```python
import torch

def _softmax(x, axis=-1):
    return torch.softmax(x, dim=axis)
def _gelu(x):
    return torch.nn.functional.gelu(x, approximate="tanh")
def _silu(x):
    return torch.nn.functional.silu(x)
def _sigmoid(x):
    return torch.sigmoid(x)
def _layernorm(x, axis=-1, eps=1e-5):
    m = x.mean(dim=axis, keepdim=True)
    v = x.var(dim=axis, keepdim=True, unbiased=False)
    return (x - m) / torch.sqrt(v + eps)
def _scatter_add(tgt, idx, src, axis=0):
    return tgt.clone().index_add_(axis, idx, src)
def _segment_sum(src, seg, n):
    out = torch.zeros((n,) + src.shape[1:], dtype=src.dtype)
    return out.index_add_(0, seg, src)
def _pad(x, pw):
    flat = tuple(v for pair in reversed(pw) for v in pair)
    return torch.nn.functional.pad(x, flat)

kernel_name = 'recurrent_scan__spectral_gfnet__dense_activation_relu__prompt'

def setup_inputs():

    _w = (lambda a: (lambda t: t.to(torch.bfloat16) if t.is_floating_point() else t)(torch.as_tensor(a)))
    def _A_setup():
        B, S, D = 1, 2048, 512
        Df = D // 2 + 1
        return {
            "x": _w((lambda *s: torch.randn(*s, dtype=torch.bfloat16) * 0.05)(B, S, D)),
            "w_r": _w((lambda *s: torch.randn(*s, dtype=torch.bfloat16) * 0.1)(S, Df) * 0.02),
            "w_i": _w((lambda *s: torch.randn(*s, dtype=torch.bfloat16) * 0.1)(S, Df) * 0.02),
        }
    _A_in = _A_setup()

    def _B_setup():
        B, S, D, Dff = 1, 2048, 512, 1792
        return {
            "x": _w((lambda *s: torch.randn(*s, dtype=torch.bfloat16) * 0.05)(B, S, D)),
            "w1": _w((lambda *s: torch.randn(*s, dtype=torch.bfloat16) * 0.05)(D, Dff)),
            "w2": _w((lambda *s: torch.randn(*s, dtype=torch.bfloat16) * 0.05)(Dff, D)),
        }
    _B_in = _B_setup()

    return {
        "A_x": _A_in["x"],
        "A_w_r": _A_in["w_r"],
        "A_w_i": _A_in["w_i"],
        "B_x": _B_in["x"],
        "B_w1": _B_in["w1"],
        "B_w2": _B_in["w2"],
    }

def reference(A_x, A_w_r, A_w_i, B_x, B_w1, B_w2):
    def _A_ref(x, w_r, w_i):
        B, S, D = x.shape
        X = (lambda x, axes=(-2,-1): torch.fft.rfft2(x.float(), dim=axes))(x, axes=(-2, -1))
        W = w_r + 1j * w_i
        X = X * W
        y = (lambda x, s, axes=(-2,-1): torch.fft.irfft2(x, s=s, dim=axes).to(torch.bfloat16))(X, (S, D), axes=(-2, -1))
        return y

    def _B_ref(x, w1, w2):
        h = torch.einsum("bsd,df->bsf", x, w1)
        zero = torch.zeros_like(h)
        h = torch.maximum(h, zero)
        return torch.einsum("bsf,fd->bsd", h, w2)

    x = A_x
    xn = _layernorm(x, axis=-1)
    s = _A_ref(xn, A_w_r, A_w_i)
    g = _silu(_B_ref(xn, B_w1, B_w2))
    return x + s * g
```

```asm
; @launch grid=(256,1,1) block=(512,1,1) lds=163840
.amdgcn_target "amdgcn-amd-amdhsa--gfx950"
.set EP_H_c0, 1
.set EP_H_c1, 2
.set EP_H_c2, 3
.set EP_H_c3, 4
.set EP_H_c4, 5
.set EP_H_c5, 6
.set EP_H_c6, 7
.set EP_H_c7, 8
.set EP_H_xc, 9
.set EP_H_w2, 10
.set EP_H_fr, 11
.set EP_H_sp1, 12
.set EP_H_ex, 13
.set EP_H_cd, 14
.set EP_H_xt, 15
.set EP_H_y0, 16
.set EP_H_y1, 17
.set EP_H_y2, 18
.set EP_H_y3, 19
.set EP_H_done, 20
.set EP_G_ga, 1
.set EP_G_rel0, 2
.set EP_G_rel1, 3
.set EP_G_rel2, 4
.set EP_G_rel3, 5
.set EP_G_rel4, 6
.set EP_G_rel5, 7
.set EP_G_rel6, 8
.set EP_G_cs, 9
.set EP_G_s01, 10
.set EP_G_t3, 11
.set EP_G_y, 12
.text
.globl recurrent_scan__spectral_gfnet__dense_activation_relu__prompt_kernel
.p2align 8
.type recurrent_scan__spectral_gfnet__dense_activation_relu__prompt_kernel,@function
recurrent_scan__spectral_gfnet__dense_activation_relu__prompt_kernel:
  s_cmp_ge_u32 s2, 256
  s_cbranch_scc1 L_end
  s_load_dwordx16 s[64:79], s[0:1], 0
  s_load_dwordx2 s[80:81], s[0:1], 64
  v_lshrrev_b32 v4, 6, v0
  v_and_b32 v26, 3, v0
  v_and_b32 v1, 63, v0
  v_readfirstlane_b32 s3, v4
  v_mov_b32 v19, 0
  v_lshlrev_b32 v18, 4, v1
  v_lshlrev_b32 v28, 2, v4
  v_add_u32 v28, 156672, v28
  ds_write_b32 v28, v19
  s_lshr_b32 s37, s2, 3
  s_and_b32 s36, s2, 7
  s_getpc_b64 s[4:5]
L_pc:
  s_and_b32 s5, s5, 0xffff
  s_mov_b32 s6, L_code_end-L_pc
  s_mov_b32 s7, 0x20000
  s_lshl_b32 s44, s37, 11
  s_lshl_b32 s45, s3, 8
  s_add_u32 s44, s44, s45
  v_lshlrev_b32 v5, 7, v1
  s_mov_b64 exec, 3
  buffer_load_dword v255, v5, s[4:7], s44 offen
  s_mov_b64 exec, -1
  s_and_b32 s38, s3, 3
  s_lshr_b32 s41, s37, 2
  s_and_b32 s42, s37, 3
  s_lshl_b32 s61, s38, 12
  s_lshl_b32 s62, s38, 13
  s_and_b32 s21, s37, 1
  s_lshr_b32 s22, s37, 1
  v_and_b32 v16, 15, v0
  v_lshrrev_b32 v17, 4, v1
  v_lshrrev_b32 v21, 5, v1
  v_and_b32 v22, 31, v1
  v_bfe_u32 v23, v1, 2, 2
  v_lshlrev_b32 v27, 2, v26
  v_add_u32 v27, 156672, v27
  s_cmp_lt_u32 s3, 4
  s_cbranch_scc1 L_G
  s_setprio 1
  v_lshlrev_b32 v4, 14, v21
  v_bfe_u32 v5, v1, 3, 2
  v_lshl_add_u32 v4, v5, 10, v4
  v_and_b32 v7, 7, v1
  v_xor_b32 v5, v7, v17
  v_lshl_add_u32 v32, v5, 4, v4
  v_xor_b32 v6, 64, v32
  v_add_u32 v33, 31744, v6
  v_add_u32 v34, 63488, v32
  v_add_u32 v35, 95232, v6
  v_mul_u32_u24 v4, 3584, v17
  v_xor_b32 v5, v23, v17
  v_lshl_add_u32 v4, v5, 6, v4
  v_lshl_add_u32 v36, v26, 4, v4
  v_add_u32 v37, 13312, v36
  v_add_u32 v38, 26624, v36
  v_add_u32 v39, 39936, v36
  s_lshl_b32 s54, s36, 8
  s_and_b32 s44, s38, 1
  s_lshl_b32 s44, s44, 7
  s_add_u32 s54, s54, s44
  s_lshl_b32 s44, s21, 3
  s_add_u32 s54, s54, s44
  s_lshr_b32 s44, s38, 1
  s_lshl_b32 s44, s44, 2
  s_add_u32 s54, s54, s44
  s_lshl_b32 s54, s54, 10
  s_mul_i32 s55, s38, 57344
  s_lshl_b32 s44, s22, 8
  s_add_u32 s55, s55, s44
  s_mov_b32 s53, s36
  s_lshr_b32 s44, s36, 1
  s_lshl_b32 s44, s44, 4
  s_and_b32 s45, s37, 15
  s_add_u32 s44, s44, s45
  s_and_b32 s45, s36, 1
  s_lshl_b32 s45, s45, 1
  s_lshr_b32 s46, s37, 4
  s_add_u32 s45, s45, s46
  s_lshl_b32 s45, s45, 9
  s_add_u32 s44, s44, s45
  s_lshl_b32 s45, s38, 7
  s_add_u32 s44, s44, s45
  s_mul_i32 s50, s44, 514
  s_add_u32 s51, s50, 32896
  v_lshlrev_b32 v50, 3, v1
  v_and_b32 v4, 1, v1
  v_mul_u32_u24 v51, 32896, v4
  s_waitcnt lgkmcnt(0)
  s_mov_b32 s12, s64
  s_and_b32 s13, s65, 0xffff
  s_mov_b32 s14, 2097152
  s_mov_b32 s15, 0x20000
  s_mov_b32 s16, s72
  s_and_b32 s17, s73, 0xffff
  s_mov_b32 s18, 1835008
  s_mov_b32 s19, 0x20000
  s_cmp_lt_u32 s37, 28
  s_cselect_b32 s14, s14, 0
  s_cselect_b32 s18, s18, 0
  s_mov_b32 s8, s66
  s_and_b32 s9, s67, 0xffff
  s_mov_b32 s10, 1052672
  s_mov_b32 s11, 0x20000
  s_mov_b32 s28, s68
  s_and_b32 s29, s69, 0xffff
  s_mov_b32 s30, 1052672
  s_mov_b32 s31, 0x20000
  s_mov_b32 s32, s80
  s_and_b32 s33, s81, 0xffff
  s_mov_b32 s34, 16777216
  s_mov_b32 s35, 0x20000
  s_barrier
  buffer_load_dword v29, v19, s[32:35], 0 offen sc1
  s_mul_i32 s52, s53, 229376
  s_add_u32 s52, s52, s55
  s_add_u32 m0, s61, 16384
  s_nop 0
  buffer_load_dwordx4 v36, s[16:19], s52 offen offset:0 lds
  buffer_load_dwordx4 v37, s[16:19], s52 offen offset:1024 lds
  buffer_load_dwordx4 v38, s[16:19], s52 offen offset:2048 lds
  buffer_load_dwordx4 v39, s[16:19], s52 offen offset:3072 lds
  s_mul_i32 s52, s53, 128
  s_add_u32 s52, s52, s54
  s_add_u32 m0, s61, 0
  s_nop 0
  buffer_load_dwordx4 v32, s[12:15], s52 offen offset:0 lds
  buffer_load_dwordx4 v33, s[12:15], s52 offen offset:1024 lds
  buffer_load_dwordx4 v34, s[12:15], s52 offen offset:2048 lds
  buffer_load_dwordx4 v35, s[12:15], s52 offen offset:3072 lds
  s_add_u32 s53, s53, 1
  s_and_b32 s53, s53, 7
  buffer_load_dwordx2 v[40:41], v50, s[8:11], s50 offen
  buffer_load_dwordx2 v[42:43], v50, s[28:31], s50 offen
  buffer_load_dwordx2 v[44:45], v50, s[8:11], s51 offen
  buffer_load_dwordx2 v[46:47], v50, s[28:31], s51 offen
  s_mov_b64 exec, 3
  buffer_load_ushort v48, v51, s[8:11], s50 offen offset:512
  buffer_load_ushort v49, v51, s[28:31], s50 offen offset:512
  s_mov_b64 exec, -1
  s_mul_i32 s52, s53, 229376
  s_add_u32 s52, s52, s55
  s_add_u32 m0, s61, 49152
  s_nop 0
  buffer_load_dwordx4 v36, s[16:19], s52 offen offset:0 lds
  buffer_load_dwordx4 v37, s[16:19], s52 offen offset:1024 lds
  buffer_load_dwordx4 v38, s[16:19], s52 offen offset:2048 lds
  buffer_load_dwordx4 v39, s[16:19], s52 offen offset:3072 lds
  s_mul_i32 s52, s53, 128
  s_add_u32 s52, s52, s54
  s_add_u32 m0, s61, 32768
  s_nop 0
  buffer_load_dwordx4 v32, s[12:15], s52 offen offset:0 lds
  buffer_load_dwordx4 v33, s[12:15], s52 offen offset:1024 lds
  buffer_load_dwordx4 v34, s[12:15], s52 offen offset:2048 lds
  buffer_load_dwordx4 v35, s[12:15], s52 offen offset:3072 lds
  s_add_u32 s53, s53, 1
  s_and_b32 s53, s53, 7
  s_branch L_H2
L_G:
  s_setprio 3
  s_lshl_b32 s44, s36, 8
  s_lshl_b32 s45, s38, 6
  s_add_u32 s44, s44, s45
  s_add_u32 s63, s44, s37
  s_lshl_b32 s50, s63, 10
  s_add_u32 s51, s50, 32768
  v_mov_b32 v58, 0xbb000000
  s_lshr_b32 s49, s61, 1
  s_add_u32 s49, s49, 131072
  v_add_u32 v59, s49, v18
  v_lshrrev_b32 v5, 2, v1
  v_lshlrev_b32 v6, 3, v26
  v_lshl_add_u32 v5, v5, 6, v6
  v_add_u32 v112, s49, v5
  v_mul_u32_u24 v4, 272, v1
  s_lshl_b32 s49, s38, 3
  s_add_u32 s49, s49, 139264
  v_add_u32 v113, s49, v4
  v_cvt_f32_u32 v56, v16
  v_lshlrev_b32 v4, 2, v17
  v_cvt_f32_u32 v57, v4
  v_mul_f32 v5, 0x3d800000, v56
  v_mul_f32 v60, v5, v57
  v_add_f32 v61, v60, v5
  v_add_f32 v62, v61, v5
  v_add_f32 v63, v62, v5
  v_cos_f32 v104, v60
  v_sin_f32 v108, v60
  v_cos_f32 v105, v61
  v_sin_f32 v109, v61
  s_waitcnt lgkmcnt(0)
  s_mov_b32 s8, s64
  s_and_b32 s9, s65, 0xffff
  s_mov_b32 s10, 2097152
  s_mov_b32 s11, 0x20000
  buffer_load_dwordx4 v[116:119], v18, s[8:11], s50 offen
  buffer_load_dwordx4 v[120:123], v18, s[8:11], s51 offen
  s_mov_b32 s32, s80
  s_and_b32 s33, s81, 0xffff
  s_mov_b32 s34, 16777216
  s_mov_b32 s35, 0x20000
  buffer_load_dword v29, v19, s[32:35], 0 offen sc1
  s_barrier
  s_mov_b32 s24, s74
  s_and_b32 s25, s75, 0xffff
  s_mov_b32 s26, 1835008
  s_mov_b32 s27, 0x20000
  s_mov_b32 s28, s76
  s_and_b32 s29, s77, 0xffff
  s_mov_b32 s30, 2097152
  s_mov_b32 s31, 0x20000
  v_cos_f32 v106, v62
  v_sin_f32 v110, v62
  v_cos_f32 v107, v63
  v_sin_f32 v111, v63
  v_mul_f32 v6, 0x3d000000, v56
  v_cvt_pk_bf16_f32 v64, v104, v105
  v_cvt_pk_bf16_f32 v65, v106, v107
  v_cvt_pk_bf16_f32 v66, -v108, -v109
  v_cvt_pk_bf16_f32 v67, -v110, -v111
  v_mul_f32 v7, 0x3d000000, v60
  v_add_f32 v8, v7, v6
  v_cos_f32 v68, v7
  v_sin_f32 v76, v7
  v_cos_f32 v72, v8
  v_sin_f32 v80, v8
  v_mul_f32 v7, 0x3d000000, v61
  v_add_f32 v8, v7, v6
  v_cos_f32 v69, v7
  v_sin_f32 v77, v7
  v_cos_f32 v73, v8
  v_sin_f32 v81, v8
  v_mul_f32 v7, 0x3d000000, v62
  v_add_f32 v8, v7, v6
  v_cos_f32 v70, v7
  v_sin_f32 v78, v7
  v_cos_f32 v74, v8
  v_sin_f32 v82, v8
  v_mul_f32 v7, 0x3d000000, v63
  v_add_f32 v8, v7, v6
  v_cos_f32 v71, v7
  v_sin_f32 v79, v7
  v_cos_f32 v75, v8
  v_sin_f32 v83, v8
  v_mul_f32 v4, 0x3d000000, v56
  v_mul_f32 v5, v4, v57
  v_and_b32 v6, 1, v1
  v_mul_u32_u24 v6, 0x8000, v6
  v_lshl_or_b32 v6, v6, 16, v6
  v_cos_f32 v104, v5
  v_sin_f32 v105, v5
  v_add_f32 v5, v5, v4
  v_cvt_pk_bf16_f32 v84, v104, v105
  v_cvt_pk_bf16_f32 v88, -v105, v104
  v_xor_b32 v92, v6, v84
  v_xor_b32 v96, v6, v88
  v_cos_f32 v104, v5
  v_sin_f32 v105, v5
  v_add_f32 v5, v5, v4
  v_cvt_pk_bf16_f32 v85, v104, v105
  v_cvt_pk_bf16_f32 v89, -v105, v104
  v_xor_b32 v93, v6, v85
  v_xor_b32 v97, v6, v89
  v_cos_f32 v104, v5
  v_sin_f32 v105, v5
  v_add_f32 v5, v5, v4
  v_cvt_pk_bf16_f32 v86, v104, v105
  v_cvt_pk_bf16_f32 v90, -v105, v104
  v_xor_b32 v94, v6, v86
  v_xor_b32 v98, v6, v90
  v_cos_f32 v104, v5
  v_sin_f32 v105, v5
  s_nop 0
  v_cvt_pk_bf16_f32 v87, v104, v105
  v_cvt_pk_bf16_f32 v91, -v105, v104
  v_xor_b32 v95, v6, v87
  v_xor_b32 v99, v6, v91
  v_mov_b32 v100, 0x3f80
  v_mov_b32 v101, 0xbf80
  v_mov_b32 v102, 0x3f80
  v_mov_b32 v103, 0xbf80
  v_and_b32 v4, 1, v17
  v_lshlrev_b32 v5, 5, v4
  v_lshl_add_u32 v24, v26, 3, v5
  v_lshrrev_b32 v5, 3, v22
  v_lshlrev_b32 v5, 5, v5
  v_bfe_u32 v6, v1, 2, 1
  v_lshl_add_u32 v5, v6, 4, v5
  v_add_u32 v25, v5, v26
  v_lshlrev_b32 v5, 2, v4
  v_and_b32 v6, 7, v1
  v_xor_b32 v5, v5, v6
  v_lshlrev_b32 v30, 4, v5
  v_lshrrev_b32 v6, 3, v1
  v_lshl_add_u32 v12, v6, 10, v30
  v_add_u32 v13, 7168, v12
  v_add_u32 v14, 14336, v12
  v_add_u32 v15, 21504, v12
  v_lshl_add_u32 v5, v21, 2, v23
  v_lshl_add_u32 v5, v5, 7, v24
  v_lshrrev_b32 v6, 1, v23
  v_lshl_add_u32 v31, v6, 6, v5
  s_mul_i32 s7, s38, 458752
  s_lshl_b32 s20, s41, 7
  s_add_u32 s7, s7, s20
  s_mov_b32 s20, s36
  s_mul_i32 s23, s20, 37
  s_lshr_b32 s23, s23, 8
  s_mul_i32 s23, s23, 7
  s_sub_u32 s20, s20, s23
  s_lshl_b32 s44, s36, 5
  s_add_u32 s44, s44, s37
  s_lshl_b32 s55, s44, 7
  s_add_u32 s55, s55, 1048576
  s_lshl_b32 s53, s44, 5
  s_add_u32 s53, s53, 327680
  s_lshl_b32 s54, s44, 4
  s_add_u32 s54, s54, 114688
  s_lshl_b32 s4, s38, 8
  s_add_u32 s4, s4, s44
  s_lshl_b32 s4, s4, 4
  s_add_u32 s4, s4, 16384
  s_lshl_b32 s45, s38, 2
  v_add_u32 v5, s45, v17
  v_mul_u32_u24 v7, 272, v5
  v_lshl_add_u32 v7, v16, 4, v7
  v_add_u32 v114, 139264, v7
  v_lshlrev_b32 v8, 18, v5
  v_lshrrev_b32 v9, 3, v16
  v_lshl_add_u32 v8, v9, 15, v8
  v_and_b32 v6, 7, v1
  v_lshl_add_u32 v115, v6, 4, v8
  s_and_b32 s56, s38, 1
  s_lshr_b32 s57, s38, 1
  s_lshl_b32 s44, s56, 13
  v_lshlrev_b32 v4, 7, v22
  v_add_u32 v4, s44, v4
  v_bfe_u32 v5, v1, 1, 3
  v_xor_b32 v5, v5, v21
  s_lshl_b32 s45, s56, 2
  v_xor_b32 v5, s45, v5
  v_lshl_add_u32 v36, v5, 4, v4
  v_lshl_add_u32 v4, v21, 3, v23
  v_lshl_add_u32 v4, v4, 8, v24
  s_lshl_b32 s45, s57, 1
  v_xor_b32 v5, s45, v23
  v_lshl_add_u32 v4, v5, 6, v4
  s_add_u32 s45, s44, 16384
  s_sub_u32 s46, 16384, s44
  v_add_u32 v40, s45, v4
  v_xor_b32 v41, 64, v40
  v_add_u32 v42, s46, v4
  v_xor_b32 v43, 64, v42
  v_xor_b32 v37, 32, v36
  v_xor_b32 v38, 64, v36
  v_xor_b32 v39, 96, v36
  v_and_b32 v4, 1, v17
  v_cmp_eq_u32 vcc, v4, v16
  v_mov_b32 v5, 0x3f803f80
  s_nop 0
  v_cndmask_b32 v52, 0, v5, vcc
  v_cndmask_b32 v53, 0, v5, vcc
  v_cndmask_b32 v54, 0, v5, vcc
  v_cndmask_b32 v55, 0, v5, vcc
  s_waitcnt vmcnt(2)
  v_lshlrev_b32 v124, 16, v116
  v_and_b32 v125, 0xffff0000, v116
  v_lshlrev_b32 v126, 16, v117
  v_and_b32 v127, 0xffff0000, v117
  v_lshlrev_b32 v128, 16, v118
  v_and_b32 v129, 0xffff0000, v118
  v_lshlrev_b32 v130, 16, v119
  v_and_b32 v131, 0xffff0000, v119
  s_waitcnt vmcnt(1)
  v_lshlrev_b32 v132, 16, v120
  v_and_b32 v133, 0xffff0000, v120
  v_lshlrev_b32 v134, 16, v121
  v_and_b32 v135, 0xffff0000, v121
  v_lshlrev_b32 v136, 16, v122
  v_and_b32 v137, 0xffff0000, v122
  v_lshlrev_b32 v138, 16, v123
  v_and_b32 v139, 0xffff0000, v123
  v_pk_add_f32 v[4:5], v[124:125], v[126:127]
  v_pk_add_f32 v[6:7], v[128:129], v[130:131]
  v_pk_add_f32 v[4:5], v[4:5], v[6:7]
  v_add_f32 v140, v4, v5
  v_pk_add_f32 v[8:9], v[132:133], v[134:135]
  v_pk_add_f32 v[10:11], v[136:137], v[138:139]
  v_pk_add_f32 v[8:9], v[8:9], v[10:11]
  v_add_f32 v141, v8, v9
  v_add_f32_dpp v140, v140, v140 row_shr:1 row_mask:0xf bank_mask:0xf bound_ctrl:0
  s_nop 0
  v_add_f32_dpp v141, v141, v141 row_shr:1 row_mask:0xf bank_mask:0xf bound_ctrl:0
  v_add_f32_dpp v140, v140, v140 row_shr:2 row_mask:0xf bank_mask:0xf bound_ctrl:0
  s_nop 0
  v_add_f32_dpp v141, v141, v141 row_shr:2 row_mask:0xf bank_mask:0xf bound_ctrl:0
  v_add_f32_dpp v140, v140, v140 row_shr:4 row_mask:0xf bank_mask:0xf bound_ctrl:0
  s_nop 0
  v_add_f32_dpp v141, v141, v141 row_shr:4 row_mask:0xf bank_mask:0xf bound_ctrl:0
  v_add_f32_dpp v140, v140, v140 row_shr:8 row_mask:0xf bank_mask:0xf bound_ctrl:0
  s_nop 0
  v_add_f32_dpp v141, v141, v141 row_shr:8 row_mask:0xf bank_mask:0xf bound_ctrl:0
  v_add_f32_dpp v140, v140, v140 row_bcast:15 row_mask:0xa bank_mask:0xf
  s_nop 0
  v_add_f32_dpp v141, v141, v141 row_bcast:15 row_mask:0xa bank_mask:0xf
  v_add_f32_dpp v140, v140, v140 row_bcast:31 row_mask:0xc bank_mask:0xf
  s_nop 0
  v_add_f32_dpp v141, v141, v141 row_bcast:31 row_mask:0xc bank_mask:0xf
  v_readlane_b32 s44, v140, 63
  v_readlane_b32 s45, v141, 63
  s_nop 0
  v_mul_f32 v152, s44, v58
  v_mul_f32 v154, s45, v58
  v_pk_add_f32 v[144:145], v[124:125], v[152:153] op_sel_hi:[1,0]
  v_pk_add_f32 v[146:147], v[126:127], v[152:153] op_sel_hi:[1,0]
  v_pk_add_f32 v[148:149], v[128:129], v[152:153] op_sel_hi:[1,0]
  v_pk_add_f32 v[150:151], v[130:131], v[152:153] op_sel_hi:[1,0]
  v_pk_mul_f32 v[4:5], v[144:145], v[144:145]
  v_pk_fma_f32 v[4:5], v[146:147], v[146:147], v[4:5]
  v_pk_fma_f32 v[4:5], v[148:149], v[148:149], v[4:5]
  v_pk_fma_f32 v[4:5], v[150:151], v[150:151], v[4:5]
  v_add_f32 v140, v4, v5
  v_pk_add_f32 v[144:145], v[132:133], v[154:155] op_sel_hi:[1,0]
  v_pk_add_f32 v[146:147], v[134:135], v[154:155] op_sel_hi:[1,0]
  v_pk_add_f32 v[148:149], v[136:137], v[154:155] op_sel_hi:[1,0]
  v_pk_add_f32 v[150:151], v[138:139], v[154:155] op_sel_hi:[1,0]
  v_pk_mul_f32 v[6:7], v[144:145], v[144:145]
  v_pk_fma_f32 v[6:7], v[146:147], v[146:147], v[6:7]
  v_pk_fma_f32 v[6:7], v[148:149], v[148:149], v[6:7]
  v_pk_fma_f32 v[6:7], v[150:151], v[150:151], v[6:7]
  v_add_f32 v141, v6, v7
  v_add_f32_dpp v140, v140, v140 row_shr:1 row_mask:0xf bank_mask:0xf bound_ctrl:0
  s_nop 0
  v_add_f32_dpp v141, v141, v141 row_shr:1 row_mask:0xf bank_mask:0xf bound_ctrl:0
  v_add_f32_dpp v140, v140, v140 row_shr:2 row_mask:0xf bank_mask:0xf bound_ctrl:0
  s_nop 0
  v_add_f32_dpp v141, v141, v141 row_shr:2 row_mask:0xf bank_mask:0xf bound_ctrl:0
  v_add_f32_dpp v140, v140, v140 row_shr:4 row_mask:0xf bank_mask:0xf bound_ctrl:0
  s_nop 0
  v_add_f32_dpp v141, v141, v141 row_shr:4 row_mask:0xf bank_mask:0xf bound_ctrl:0
  v_add_f32_dpp v140, v140, v140 row_shr:8 row_mask:0xf bank_mask:0xf bound_ctrl:0
  s_nop 0
  v_add_f32_dpp v141, v141, v141 row_shr:8 row_mask:0xf bank_mask:0xf bound_ctrl:0
  v_add_f32_dpp v140, v140, v140 row_bcast:15 row_mask:0xa bank_mask:0xf
  s_nop 0
  v_add_f32_dpp v141, v141, v141 row_bcast:15 row_mask:0xa bank_mask:0xf
  v_add_f32_dpp v140, v140, v140 row_bcast:31 row_mask:0xc bank_mask:0xf
  s_nop 0
  v_add_f32_dpp v141, v141, v141 row_bcast:31 row_mask:0xc bank_mask:0xf
  v_readlane_b32 s46, v140, 63
  v_readlane_b32 s47, v141, 63
  s_nop 0
  v_mul_f32 v4, s46, v58
  v_mul_f32 v8, s47, v58
  v_cvt_pk_bf16_f32 v4, -v4, -v4
  v_cvt_pk_bf16_f32 v8, -v8, -v8
  v_lshlrev_b32 v4, 16, v4
  v_lshlrev_b32 v8, 16, v8
  v_add_f32 v4, 0x3727c5ac, v4
  v_add_f32 v8, 0x3727c5ac, v8
  v_cvt_pk_bf16_f32 v4, v4, v4
  v_cvt_pk_bf16_f32 v8, v8, v8
  v_lshlrev_b32 v4, 16, v4
  v_lshlrev_b32 v8, 16, v8
  v_sqrt_f32 v4, v4
  v_sqrt_f32 v8, v8
  v_cvt_pk_bf16_f32 v142, v4, -v152
  v_cvt_pk_bf16_f32 v143, v8, -v154
  v_lshlrev_b32 v4, 16, v142
  v_lshlrev_b32 v8, 16, v143
  v_rcp_f32 v156, v4
  v_rcp_f32 v158, v8
  v_and_b32 v5, 0xffff0000, v142
  v_and_b32 v9, 0xffff0000, v143
  v_mul_f32 v160, v5, v156
  v_mul_f32 v162, v9, v158
  v_pk_fma_f32 v[124:125], v[124:125], v[156:157], v[160:161] op_sel_hi:[1,0,0] neg_lo:[0,0,1] neg_hi:[0,0,1]
  v_pk_fma_f32 v[126:127], v[126:127], v[156:157], v[160:161] op_sel_hi:[1,0,0] neg_lo:[0,0,1] neg_hi:[0,0,1]
  v_pk_fma_f32 v[128:129], v[128:129], v[156:157], v[160:161] op_sel_hi:[1,0,0] neg_lo:[0,0,1] neg_hi:[0,0,1]
  v_pk_fma_f32 v[130:131], v[130:131], v[156:157], v[160:161] op_sel_hi:[1,0,0] neg_lo:[0,0,1] neg_hi:[0,0,1]
  v_cvt_pk_bf16_f32 v116, v124, v125
  v_cvt_pk_bf16_f32 v117, v126, v127
  v_cvt_pk_bf16_f32 v118, v128, v129
  v_cvt_pk_bf16_f32 v119, v130, v131
  ds_write_b128 v59, v[116:119] offset:0
  ds_read_b64_tr_b16 v[164:165], v112 offset:0
  ds_read_b64_tr_b16 v[166:167], v112 offset:32
  v_pk_fma_f32 v[132:133], v[132:133], v[158:159], v[162:163] op_sel_hi:[1,0,0] neg_lo:[0,0,1] neg_hi:[0,0,1]
  v_pk_fma_f32 v[134:135], v[134:135], v[158:159], v[162:163] op_sel_hi:[1,0,0] neg_lo:[0,0,1] neg_hi:[0,0,1]
  v_pk_fma_f32 v[136:137], v[136:137], v[158:159], v[162:163] op_sel_hi:[1,0,0] neg_lo:[0,0,1] neg_hi:[0,0,1]
  v_pk_fma_f32 v[138:139], v[138:139], v[158:159], v[162:163] op_sel_hi:[1,0,0] neg_lo:[0,0,1] neg_hi:[0,0,1]
  v_cvt_pk_bf16_f32 v120, v132, v133
  v_cvt_pk_bf16_f32 v121, v134, v135
  v_cvt_pk_bf16_f32 v122, v136, v137
  v_cvt_pk_bf16_f32 v123, v138, v139
  ds_write_b128 v59, v[120:123] offset:1024
  ds_read_b64_tr_b16 v[168:169], v112 offset:1024
  ds_read_b64_tr_b16 v[170:171], v112 offset:1056
  s_waitcnt vmcnt(0)
  v_readfirstlane_b32 s48, v29
  s_nop 0
  s_mul_i32 s39, s48, 0x9E3779B1
  s_add_u32 s39, s39, 0x7F4A7C15
  v_mov_b32 v20, s39
  v_cmp_eq_u32 vcc, 0, v1
  v_mov_b32 v57, s39
  v_lshlrev_b32 v58, 8, v1
  v_cndmask_b32 v56, v143, v142, vcc
  s_lshl_b32 s50, s63, 3
  s_add_u32 s50, s50, 98304
  s_waitcnt lgkmcnt(4)
  v_mfma_f32_16x16x16_bf16 v[60:63], v[164:165], v[64:65], 0
  v_mfma_f32_16x16x16_bf16 v[104:107], v[164:165], v[66:67], 0
  s_waitcnt lgkmcnt(3)
  v_mfma_f32_16x16x16_bf16 v[108:111], v[166:167], v[64:65], 0
  v_mfma_f32_16x16x16_bf16 v[124:127], v[166:167], v[66:67], 0
  s_waitcnt lgkmcnt(1)
  v_mfma_f32_16x16x16_bf16 v[128:131], v[168:169], v[64:65], 0
  v_mfma_f32_16x16x16_bf16 v[132:135], v[168:169], v[66:67], 0
  s_waitcnt lgkmcnt(0)
  v_mfma_f32_16x16x16_bf16 v[136:139], v[170:171], v[64:65], 0
  v_mfma_f32_16x16x16_bf16 v[144:147], v[170:171], v[66:67], 0
  v_mul_f32 v4, v60, v68
  v_mul_f32 v5, v104, v68
  v_fmac_f32 v4, v104, v76
  v_fma_f32 v5, -v60, v76, v5
  v_cvt_pk_bf16_f32 v148, v4, v5
  v_mul_f32 v6, v61, v69
  v_mul_f32 v7, v105, v69
  v_fmac_f32 v6, v105, v77
  v_fma_f32 v7, -v61, v77, v7
  v_cvt_pk_bf16_f32 v149, v6, v7
  v_mul_f32 v4, v62, v70
  v_mul_f32 v5, v106, v70
  v_fmac_f32 v4, v106, v78
  v_fma_f32 v5, -v62, v78, v5
  v_cvt_pk_bf16_f32 v150, v4, v5
  v_mul_f32 v6, v63, v71
  v_mul_f32 v7, v107, v71
  v_fmac_f32 v6, v107, v79
  v_fma_f32 v7, -v63, v79, v7
  v_cvt_pk_bf16_f32 v151, v6, v7
  v_mul_f32 v4, v108, v72
  v_mul_f32 v5, v124, v72
  v_fmac_f32 v4, v124, v80
  v_fma_f32 v5, -v108, v80, v5
  v_cvt_pk_bf16_f32 v152, v4, v5
  v_mul_f32 v6, v109, v73
  v_mul_f32 v7, v125, v73
  v_fmac_f32 v6, v125, v81
  v_fma_f32 v7, -v109, v81, v7
  v_cvt_pk_bf16_f32 v153, v6, v7
  v_mul_f32 v4, v110, v74
  v_mul_f32 v5, v126, v74
  v_fmac_f32 v4, v126, v82
  v_fma_f32 v5, -v110, v82, v5
  v_cvt_pk_bf16_f32 v154, v4, v5
  v_mul_f32 v6, v111, v75
  v_mul_f32 v7, v127, v75
  v_fmac_f32 v6, v127, v83
  v_fma_f32 v7, -v111, v83, v7
  v_cvt_pk_bf16_f32 v155, v6, v7
  v_mfma_f32_16x16x32_bf16 v[172:175], v[148:151], v[84:87], 0
  s_nop 0
  v_mfma_f32_16x16x32_bf16 v[172:175], v[152:155], v[92:95], v[172:175]
  v_mfma_f32_16x16x32_bf16 v[176:179], v[148:151], v[88:91], 0
  v_mfma_f32_16x16x32_bf16 v[176:179], v[152:155], v[96:99], v[176:179]
  v_mfma_f32_16x16x32_bf16 v[180:183], v[148:151], v[100:103], 0
  v_mfma_f32_16x16x32_bf16 v[180:183], v[152:155], v[100:103], v[180:183]
  v_mul_f32 v4, v128, v68
  v_mul_f32 v5, v132, v68
  v_fmac_f32 v4, v132, v76
  v_fma_f32 v5, -v128, v76, v5
  v_cvt_pk_bf16_f32 v156, v4, v5
  v_mul_f32 v6, v129, v69
  v_mul_f32 v7, v133, v69
  v_fmac_f32 v6, v133, v77
  v_fma_f32 v7, -v129, v77, v7
  v_cvt_pk_bf16_f32 v157, v6, v7
  v_mul_f32 v4, v130, v70
  v_mul_f32 v5, v134, v70
  v_fmac_f32 v4, v134, v78
  v_fma_f32 v5, -v130, v78, v5
  v_cvt_pk_bf16_f32 v158, v4, v5
  v_mul_f32 v6, v131, v71
  v_mul_f32 v7, v135, v71
  v_fmac_f32 v6, v135, v79
  v_fma_f32 v7, -v131, v79, v7
  v_cvt_pk_bf16_f32 v159, v6, v7
  v_mul_f32 v4, v136, v72
  v_mul_f32 v5, v144, v72
  v_fmac_f32 v4, v144, v80
  v_fma_f32 v5, -v136, v80, v5
  v_cvt_pk_bf16_f32 v160, v4, v5
  v_mul_f32 v6, v137, v73
  v_mul_f32 v7, v145, v73
  v_fmac_f32 v6, v145, v81
  v_fma_f32 v7, -v137, v81, v7
  v_cvt_pk_bf16_f32 v161, v6, v7
  v_mul_f32 v4, v138, v74
  v_mul_f32 v5, v146, v74
  v_fmac_f32 v4, v146, v82
  v_fma_f32 v5, -v138, v82, v5
  v_cvt_pk_bf16_f32 v162, v4, v5
  v_mul_f32 v6, v139, v75
  v_mul_f32 v7, v147, v75
  v_fmac_f32 v6, v147, v83
  v_fma_f32 v7, -v139, v83, v7
  v_cvt_pk_bf16_f32 v163, v6, v7
  v_mfma_f32_16x16x32_bf16 v[184:187], v[156:159], v[84:87], 0
  s_nop 0
  v_mfma_f32_16x16x32_bf16 v[184:187], v[160:163], v[92:95], v[184:187]
  v_mfma_f32_16x16x32_bf16 v[188:191], v[156:159], v[88:91], 0
  v_mfma_f32_16x16x32_bf16 v[188:191], v[160:163], v[96:99], v[188:191]
  v_mfma_f32_16x16x32_bf16 v[192:195], v[156:159], v[100:103], 0
  v_mfma_f32_16x16x32_bf16 v[192:195], v[160:163], v[100:103], v[192:195]
  v_add_u32 v44, 0x10000, v36
  v_add_u32 v48, 0x10000, v40
  v_add_u32 v45, 0x10000, v37
  v_add_u32 v49, 0x10000, v41
  v_add_u32 v46, 0x10000, v38
  v_add_u32 v50, 0x10000, v42
  v_add_u32 v47, 0x10000, v39
  v_add_u32 v51, 0x10000, v43
  v_cndmask_b32 v176, v176, v180, vcc
  v_cvt_pk_bf16_f32 v196, v172, v176
  v_cvt_pk_bf16_f32 v198, v173, v177
  v_cvt_pk_bf16_f32 v200, v174, v178
  v_cvt_pk_bf16_f32 v202, v175, v179
  v_cndmask_b32 v188, v188, v192, vcc
  v_cvt_pk_bf16_f32 v197, v184, v188
  v_cvt_pk_bf16_f32 v199, v185, v189
  v_cvt_pk_bf16_f32 v201, v186, v190
  v_cvt_pk_bf16_f32 v203, v187, v191
  ds_write_b64 v113, v[196:197] offset:0
  ds_write_b64 v113, v[198:199] offset:64
  ds_write_b64 v113, v[200:201] offset:128
  ds_write_b64 v113, v[202:203] offset:192
  v_mov_b32 v3, EP_G_ga
  s_mov_b64 exec, 1
  ds_write_b32 v28, v3
  s_mov_b64 exec, -1
  ds_read_b32 v2, v27 offset:0
  s_getreg_b32 s47, hwreg(HW_REG_XCC_ID, 0, 4)
  s_add_u32 s47, s47, s39
  v_mov_b32 v4, s47
  s_mov_b64 exec, 3
  buffer_store_dwordx2 v[56:57], v58, s[32:35], s50 offen sc1
  s_mov_b64 exec, 1
  s_cmp_lg_u32 s38, 0
  s_cbranch_scc1 L_noxcc
  buffer_store_dword v4, v19, s[32:35], s54 offen sc1
L_noxcc:
  s_mov_b64 exec, -1
  s_waitcnt lgkmcnt(0)
  v_cmp_gt_u32 vcc, EP_G_ga, v2
  s_nop 0
  s_cbranch_vccnz L_aslow24
L_agot24:
  ds_read_b32 v2, v27 offset:16
  s_waitcnt lgkmcnt(0)
  v_cmp_gt_u32 vcc, EP_H_c0, v2
  s_nop 0
  s_cbranch_vccnz L_aslow25
L_agot25:
  s_cmp_ge_u32 s37, 28
  s_cbranch_scc1 L_free
  s_setprio 2
  ds_read_b64_tr_b16 v[220:221], v40 offset:0
  ds_read_b64_tr_b16 v[222:223], v40 offset:1024
  ds_read_b128 v[196:199], v36 offset:0
  ds_read_b128 v[200:203], v36 offset:4096
  ds_read_b64_tr_b16 v[224:225], v41 offset:0
  ds_read_b64_tr_b16 v[226:227], v41 offset:1024
  ds_read_b128 v[104:107], v114 offset:0
  ds_read_b128 v[108:111], v114 offset:4352
  ds_read_b128 v[132:135], v114 offset:8704
  ds_read_b128 v[136:139], v114 offset:13056
  v_add_u32 v144, 156736, v18
  ds_read_b128 v[140:143], v144
  ds_read_b64_tr_b16 v[228:229], v40 offset:4096
  ds_read_b64_tr_b16 v[230:231], v40 offset:5120
  ds_read_b128 v[204:207], v37 offset:0
  ds_read_b128 v[208:211], v37 offset:4096
  ds_read_b64_tr_b16 v[232:233], v41 offset:4096
  ds_read_b64_tr_b16 v[234:235], v41 offset:5120
  s_waitcnt lgkmcnt(14)
  v_mfma_f32_32x32x16_bf16 v[56:71], v[220:223], v[196:199], 0
  ds_read_b64_tr_b16 v[236:237], v42 offset:8192
  ds_read_b64_tr_b16 v[238:239], v42 offset:9216
  s_waitcnt lgkmcnt(8)
  v_mov_b32 v144, v140
  s_cmp_lg_u32 s38, 0
  s_cbranch_scc1 L_nown26
  s_mov_b64 exec, 3
  buffer_store_dwordx4 v[140:143], v18, s[32:35], s53 offen sc1
  s_mov_b64 exec, -1
L_nown26:
  s_nop 0
  v_mfma_f32_32x32x16_bf16 v[72:87], v[220:223], v[200:203], 0
  ds_read_b128 v[212:215], v38 offset:0
  ds_read_b128 v[216:219], v38 offset:4096
  buffer_store_dwordx4 v[104:107], v115, s[32:35], s55 offen sc1
  s_add_u32 s55, s55, 65536
  s_nop 0
  v_mfma_f32_16x16x32_bf16 v[188:191], v[220:223], v[52:55], 0
  ds_read_b64_tr_b16 v[240:241], v43 offset:8192
  ds_read_b64_tr_b16 v[242:243], v43 offset:9216
  buffer_store_dwordx4 v[108:111], v115, s[32:35], s55 offen sc1
  s_add_u32 s55, s55, 65536
  s_nop 0
  v_mfma_f32_32x32x16_bf16 v[88:103], v[224:227], v[196:199], 0
  buffer_store_dwordx4 v[132:135], v115, s[32:35], s55 offen sc1
  s_add_u32 s55, s55, 65536
  s_nop 0
  v_mfma_f32_32x32x16_bf16 v[116:131], v[224:227], v[200:203], 0
  buffer_store_dwordx4 v[136:139], v115, s[32:35], s55 offen sc1
  s_nop 0
  v_mfma_f32_16x16x32_bf16 v[192:195], v[224:227], v[52:55], 0
  v_lshlrev_b32 v4, 6, v16
  v_lshl_add_u32 v4, v17, 4, v4
  s_waitcnt lgkmcnt(9)
  v_mfma_f32_32x32x16_bf16 v[56:71], v[228:231], v[204:207], v[56:71]
  ds_read_b64_tr_b16 v[220:221], v42 offset:12288
  ds_read_b64_tr_b16 v[222:223], v42 offset:13312
  s_lshl_b32 s44, s38, 8
  s_add_u32 s45, s44, 156928
  s_waitcnt lgkmcnt(10)
  v_mfma_f32_32x32x16_bf16 v[72:87], v[228:231], v[208:211], v[72:87]
  ds_read_b128 v[196:199], v39 offset:0
  ds_read_b128 v[200:203], v39 offset:4096
  v_add_u32 v112, s45, v4
  s_add_u32 s45, s44, 157952
  v_mfma_f32_16x16x32_bf16 v[188:191], v[228:231], v[52:55], v[188:191]
  ds_read_b64_tr_b16 v[224:225], v43 offset:12288
  ds_read_b64_tr_b16 v[226:227], v43 offset:13312
  v_mov_b32 v3, EP_G_rel0
  s_mov_b64 exec, 1
  ds_write_b32 v28, v3
  s_mov_b64 exec, -1
  ds_read_b32 v2, v27 offset:16
  v_lshl_add_u32 v244, v22, 2, s45
  s_lshl_b32 s44, s57, 9
  s_waitcnt lgkmcnt(14)
  v_mfma_f32_32x32x16_bf16 v[88:103], v[232:235], v[204:207], v[88:103]
  s_add_u32 s44, s44, 156928
  v_lshlrev_b32 v4, 4, v21
  v_mfma_f32_32x32x16_bf16 v[116:131], v[232:235], v[208:211], v[116:131]
  v_add_u32 v113, s44, v4
  s_lshl_b32 s44, s21, 1
  v_mfma_f32_16x16x32_bf16 v[192:195], v[232:235], v[52:55], v[192:195]
  s_and_b32 s23, s38, 1
  s_add_u32 s44, s44, s23
  s_waitcnt lgkmcnt(11)
  v_mfma_f32_32x32x16_bf16 v[56:71], v[236:239], v[212:215], v[56:71]
  s_waitcnt lgkmcnt(0)
  v_cmp_gt_u32 vcc, EP_H_c1, v2
  s_nop 0
  s_cbranch_vccnz L_aslow27
L_agot27:
  ds_read_b64_tr_b16 v[228:229], v40 offset:32768
  ds_read_b64_tr_b16 v[230:231], v40 offset:33792
  s_lshl_b32 s23, s36, 2
  s_add_u32 s23, s23, s44
  v_mfma_f32_32x32x16_bf16 v[72:87], v[236:239], v[216:219], v[72:87]
  ds_read_b128 v[204:207], v36 offset:32768
  ds_read_b128 v[208:211], v36 offset:36864
  s_mul_i32 s60, s23, 229376
  s_lshl_b32 s44, s22, 14
  v_mfma_f32_32x32x16_bf16 v[88:103], v[240:243], v[212:215], v[88:103]
  ds_read_b64_tr_b16 v[232:233], v41 offset:32768
  ds_read_b64_tr_b16 v[234:235], v41 offset:33792
  s_add_u32 s60, s60, s44
  s_lshr_b32 s44, s38, 1
  v_mfma_f32_32x32x16_bf16 v[116:131], v[240:243], v[216:219], v[116:131]
  s_lshl_b32 s44, s44, 13
  s_add_u32 s60, s60, s44
  v_mfma_f32_32x32x16_bf16 v[56:71], v[220:223], v[196:199], v[56:71]
  ds_read_b64_tr_b16 v[236:237], v40 offset:36864
  ds_read_b64_tr_b16 v[238:239], v40 offset:37888
  s_add_u32 s60, s60, 8388608
  s_lshl_b32 s5, s23, 9
  v_mfma_f32_32x32x16_bf16 v[72:87], v[220:223], v[200:203], v[72:87]
  ds_read_b128 v[212:215], v37 offset:32768
  ds_read_b128 v[216:219], v37 offset:36864
  s_lshl_b32 s45, s22, 5
  s_add_u32 s5, s5, s45
  v_mfma_f32_32x32x16_bf16 v[88:103], v[224:227], v[196:199], v[88:103]
  ds_read_b64_tr_b16 v[240:241], v41 offset:36864
  ds_read_b64_tr_b16 v[242:243], v41 offset:37888
  s_lshl_b32 s45, s57, 4
  s_add_u32 s5, s5, s45
  v_mfma_f32_32x32x16_bf16 v[116:131], v[224:227], v[200:203], v[116:131]
  s_add_u32 s5, s5, 36864
  s_lshl_b32 s44, s56, 6
  s_waitcnt lgkmcnt(9)
  v_mfma_f32_32x32x16_bf16 v[56:71], v[228:231], v[204:207], v[56:71]
  ds_read_b64_tr_b16 v[220:221], v42 offset:40960
  ds_read_b64_tr_b16 v[222:223], v42 offset:41984
  v_xor_b32 v5, s44, v31
  v_add_u32 v32, s62, v5
  s_waitcnt lgkmcnt(10)
  v_mfma_f32_32x32x16_bf16 v[72:87], v[228:231], v[208:211], v[72:87]
  ds_read_b128 v[196:199], v38 offset:32768
  ds_read_b128 v[200:203], v38 offset:36864
  v_xor_b32 v33, 64, v32
  v_add_u32 v34, 0x10000, v32
  v_mfma_f32_16x16x32_bf16 v[188:191], v[228:231], v[52:55], v[188:191]
  ds_read_b64_tr_b16 v[224:225], v43 offset:40960
  ds_read_b64_tr_b16 v[226:227], v43 offset:41984
  v_add_u32 v35, 0x10000, v33
  s_waitcnt lgkmcnt(12)
  v_mfma_f32_32x32x16_bf16 v[88:103], v[232:235], v[204:207], v[88:103]
  v_mfma_f32_32x32x16_bf16 v[116:131], v[232:235], v[208:211], v[116:131]
  v_mfma_f32_16x16x32_bf16 v[192:195], v[232:235], v[52:55], v[192:195]
  s_waitcnt lgkmcnt(9)
  v_mfma_f32_32x32x16_bf16 v[56:71], v[236:239], v[212:215], v[56:71]
  ds_read_b64_tr_b16 v[228:229], v42 offset:45056
  ds_read_b64_tr_b16 v[230:231], v42 offset:46080
  s_waitcnt lgkmcnt(10)
  v_mfma_f32_32x32x16_bf16 v[72:87], v[236:239], v[216:219], v[72:87]
  ds_read_b128 v[204:207], v39 offset:32768
  ds_read_b128 v[208:211], v39 offset:36864
  v_mfma_f32_16x16x32_bf16 v[188:191], v[236:239], v[52:55], v[188:191]
  ds_read_b64_tr_b16 v[232:233], v43 offset:45056
  ds_read_b64_tr_b16 v[234:235], v43 offset:46080
  v_mov_b32 v3, EP_G_rel1
  s_mov_b64 exec, 1
  ds_write_b32 v28, v3
  s_mov_b64 exec, -1
  ds_read_b32 v2, v27 offset:16
  s_waitcnt lgkmcnt(14)
  v_mfma_f32_32x32x16_bf16 v[88:103], v[240:243], v[212:215], v[88:103]
  v_mfma_f32_32x32x16_bf16 v[116:131], v[240:243], v[216:219], v[116:131]
  v_mfma_f32_16x16x32_bf16 v[192:195], v[240:243], v[52:55], v[192:195]
  s_waitcnt lgkmcnt(11)
  v_mfma_f32_32x32x16_bf16 v[56:71], v[220:223], v[196:199], v[56:71]
  s_waitcnt lgkmcnt(0)
  v_cmp_gt_u32 vcc, EP_H_c2, v2
  s_nop 0
  s_cbranch_vccnz L_aslow28
L_agot28:
  ds_read_b64_tr_b16 v[236:237], v48 offset:0
  ds_read_b64_tr_b16 v[238:239], v48 offset:1024
  v_mfma_f32_32x32x16_bf16 v[72:87], v[220:223], v[200:203], v[72:87]
  ds_read_b128 v[212:215], v44 offset:0
  ds_read_b128 v[216:219], v44 offset:4096
  v_mfma_f32_32x32x16_bf16 v[88:103], v[224:227], v[196:199], v[88:103]
  ds_read_b64_tr_b16 v[240:241], v49 offset:0
  ds_read_b64_tr_b16 v[242:243], v49 offset:1024
  v_mfma_f32_32x32x16_bf16 v[116:131], v[224:227], v[200:203], v[116:131]
  v_mfma_f32_32x32x16_bf16 v[56:71], v[228:231], v[204:207], v[56:71]
  ds_read_b64_tr_b16 v[220:221], v48 offset:4096
  ds_read_b64_tr_b16 v[222:223], v48 offset:5120
  v_mfma_f32_32x32x16_bf16 v[72:87], v[228:231], v[208:211], v[72:87]
  ds_read_b128 v[196:199], v45 offset:0
  ds_read_b128 v[200:203], v45 offset:4096
  v_mfma_f32_32x32x16_bf16 v[88:103], v[232:235], v[204:207], v[88:103]
  ds_read_b64_tr_b16 v[224:225], v49 offset:4096
  ds_read_b64_tr_b16 v[226:227], v49 offset:5120
  s_waitcnt vmcnt(0)
  s_mov_b64 exec, 1
  buffer_store_dword v20, v19, s[32:35], s4 offen sc1
  s_mov_b64 exec, -1
  v_mfma_f32_32x32x16_bf16 v[116:131], v[232:235], v[208:211], v[116:131]
  s_waitcnt lgkmcnt(9)
  v_mfma_f32_32x32x16_bf16 v[56:71], v[236:239], v[212:215], v[56:71]
  ds_read_b64_tr_b16 v[228:229], v50 offset:8192
  ds_read_b64_tr_b16 v[230:231], v50 offset:9216
  s_waitcnt lgkmcnt(10)
  v_mfma_f32_32x32x16_bf16 v[72:87], v[236:239], v[216:219], v[72:87]
  ds_read_b128 v[204:207], v46 offset:0
  ds_read_b128 v[208:211], v46 offset:4096
  v_mfma_f32_16x16x32_bf16 v[188:191], v[236:239], v[52:55], v[188:191]
  ds_read_b64_tr_b16 v[232:233], v51 offset:8192
  ds_read_b64_tr_b16 v[234:235], v51 offset:9216
  s_waitcnt lgkmcnt(12)
  v_mfma_f32_32x32x16_bf16 v[88:103], v[240:243], v[212:215], v[88:103]
  v_mfma_f32_32x32x16_bf16 v[116:131], v[240:243], v[216:219], v[116:131]
  v_mfma_f32_16x16x32_bf16 v[192:195], v[240:243], v[52:55], v[192:195]
  s_waitcnt lgkmcnt(9)
  v_mfma_f32_32x32x16_bf16 v[56:71], v[220:223], v[196:199], v[56:71]
  ds_read_b64_tr_b16 v[236:237], v50 offset:12288
  ds_read_b64_tr_b16 v[238:239], v50 offset:13312
  s_waitcnt lgkmcnt(10)
  v_mfma_f32_32x32x16_bf16 v[72:87], v[220:223], v[200:203], v[72:87]
  ds_read_b128 v[212:215], v47 offset:0
  ds_read_b128 v[216:219], v47 offset:4096
  v_mfma_f32_16x16x32_bf16 v[188:191], v[220:223], v[52:55], v[188:191]
  ds_read_b64_tr_b16 v[240:241], v51 offset:12288
  ds_read_b64_tr_b16 v[242:243], v51 offset:13312
  v_mov_b32 v3, EP_G_rel2
  s_mov_b64 exec, 1
  ds_write_b32 v28, v3
  s_mov_b64 exec, -1
  ds_read_b32 v2, v27 offset:16
  s_waitcnt lgkmcnt(14)
  v_mfma_f32_32x32x16_bf16 v[88:103], v[224:227], v[196:199], v[88:103]
  v_mfma_f32_32x32x16_bf16 v[116:131], v[224:227], v[200:203], v[116:131]
  v_mfma_f32_16x16x32_bf16 v[192:195], v[224:227], v[52:55], v[192:195]
  s_waitcnt lgkmcnt(11)
  v_mfma_f32_32x32x16_bf16 v[56:71], v[228:231], v[204:207], v[56:71]
  s_waitcnt lgkmcnt(0)
  v_cmp_gt_u32 vcc, EP_H_c3, v2
  s_nop 0
  s_cbranch_vccnz L_aslow29
L_agot29:
  ds_read_b64_tr_b16 v[220:221], v48 offset:32768
  ds_read_b64_tr_b16 v[222:223], v48 offset:33792
  v_mfma_f32_32x32x16_bf16 v[72:87], v[228:231], v[208:211], v[72:87]
  ds_read_b128 v[196:199], v44 offset:32768
  ds_read_b128 v[200:203], v44 offset:36864
  v_mfma_f32_32x32x16_bf16 v[88:103], v[232:235], v[204:207], v[88:103]
  ds_read_b64_tr_b16 v[224:225], v49 offset:32768
  ds_read_b64_tr_b16 v[226:227], v49 offset:33792
  v_mfma_f32_32x32x16_bf16 v[116:131], v[232:235], v[208:211], v[116:131]
  v_mfma_f32_32x32x16_bf16 v[56:71], v[236:239], v[212:215], v[56:71]
  ds_read_b64_tr_b16 v[228:229], v48 offset:36864
  ds_read_b64_tr_b16 v[230:231], v48 offset:37888
  v_mfma_f32_32x32x16_bf16 v[72:87], v[236:239], v[216:219], v[72:87]
  ds_read_b128 v[204:207], v45 offset:32768
  ds_read_b128 v[208:211], v45 offset:36864
  v_mfma_f32_32x32x16_bf16 v[88:103], v[240:243], v[212:215], v[88:103]
  ds_read_b64_tr_b16 v[232:233], v49 offset:36864
  ds_read_b64_tr_b16 v[234:235], v49 offset:37888
  v_mfma_f32_32x32x16_bf16 v[116:131], v[240:243], v[216:219], v[116:131]
  s_waitcnt lgkmcnt(9)
  v_mfma_f32_32x32x16_bf16 v[56:71], v[220:223], v[196:199], v[56:71]
  ds_read_b64_tr_b16 v[236:237], v50 offset:40960
  ds_read_b64_tr_b16 v[238:239], v50 offset:41984
  s_waitcnt lgkmcnt(10)
  v_mfma_f32_32x32x16_bf16 v[72:87], v[220:223], v[200:203], v[72:87]
  ds_read_b128 v[212:215], v46 offset:32768
  ds_read_b128 v[216:219], v46 offset:36864
  v_mfma_f32_16x16x32_bf16 v[188:191], v[220:223], v[52:55], v[188:191]
  ds_read_b64_tr_b16 v[240:241], v51 offset:40960
  ds_read_b64_tr_b16 v[242:243], v51 offset:41984
  s_waitcnt lgkmcnt(12)
  v_mfma_f32_32x32x16_bf16 v[88:103], v[224:227], v[196:199], v[88:103]
  v_mfma_f32_32x32x16_bf16 v[116:131], v[224:227], v[200:203], v[116:131]
  v_mfma_f32_16x16x32_bf16 v[192:195], v[224:227], v[52:55], v[192:195]
  s_waitcnt lgkmcnt(9)
  v_mfma_f32_32x32x16_bf16 v[56:71], v[228:231], v[204:207], v[56:71]
  ds_read_b64_tr_b16 v[220:221], v50 offset:45056
  ds_read_b64_tr_b16 v[222:223], v50 offset:46080
  s_waitcnt lgkmcnt(10)
  v_mfma_f32_32x32x16_bf16 v[72:87], v[228:231], v[208:211], v[72:87]
  ds_read_b128 v[196:199], v47 offset:32768
  ds_read_b128 v[200:203], v47 offset:36864
  v_mfma_f32_16x16x32_bf16 v[188:191], v[228:231], v[52:55], v[188:191]
  ds_read_b64_tr_b16 v[224:225], v51 offset:45056
  ds_read_b64_tr_b16 v[226:227], v51 offset:46080
  v_mov_b32 v3, EP_G_rel3
  s_mov_b64 exec, 1
  ds_write_b32 v28, v3
  s_mov_b64 exec, -1
  ds_read_b32 v2, v27 offset:16
  s_waitcnt lgkmcnt(14)
  v_mfma_f32_32x32x16_bf16 v[88:103], v[232:235], v[204:207], v[88:103]
  v_mfma_f32_32x32x16_bf16 v[116:131], v[232:235], v[208:211], v[116:131]
  v_mfma_f32_16x16x32_bf16 v[192:195], v[232:235], v[52:55], v[192:195]
  s_waitcnt lgkmcnt(11)
  v_mfma_f32_32x32x16_bf16 v[56:71], v[236:239], v[212:215], v[56:71]
  s_waitcnt lgkmcnt(0)
  v_cmp_gt_u32 vcc, EP_H_c4, v2
  s_nop 0
  s_cbranch_vccnz L_aslow30
L_agot30:
  ds_read_b64_tr_b16 v[228:229], v40 offset:0
  ds_read_b64_tr_b16 v[230:231], v40 offset:1024
  v_mfma_f32_32x32x16_bf16 v[72:87], v[236:239], v[216:219], v[72:87]
  ds_read_b128 v[204:207], v36 offset:0
  ds_read_b128 v[208:211], v36 offset:4096
  v_mfma_f32_32x32x16_bf16 v[88:103], v[240:243], v[212:215], v[88:103]
  ds_read_b64_tr_b16 v[232:233], v41 offset:0
  ds_read_b64_tr_b16 v[234:235], v41 offset:1024
  v_mfma_f32_32x32x16_bf16 v[116:131], v[240:243], v[216:219], v[116:131]
  v_mfma_f32_32x32x16_bf16 v[56:71], v[220:223], v[196:199], v[56:71]
  ds_read_b64_tr_b16 v[236:237], v40 offset:4096
  ds_read_b64_tr_b16 v[238:239], v40 offset:5120
  v_mfma_f32_32x32x16_bf16 v[72:87], v[220:223], v[200:203], v[72:87]
  ds_read_b128 v[212:215], v37 offset:0
  ds_read_b128 v[216:219], v37 offset:4096
  v_mfma_f32_32x32x16_bf16 v[88:103], v[224:227], v[196:199], v[88:103]
  ds_read_b64_tr_b16 v[240:241], v41 offset:4096
  ds_read_b64_tr_b16 v[242:243], v41 offset:5120
  v_mfma_f32_32x32x16_bf16 v[116:131], v[224:227], v[200:203], v[116:131]
  s_waitcnt lgkmcnt(9)
  v_mfma_f32_32x32x16_bf16 v[56:71], v[228:231], v[204:207], v[56:71]
  ds_read_b64_tr_b16 v[220:221], v42 offset:8192
  ds_read_b64_tr_b16 v[222:223], v42 offset:9216
  s_waitcnt lgkmcnt(10)
  v_mfma_f32_32x32x16_bf16 v[72:87], v[228:231], v[208:211], v[72:87]
  ds_read_b128 v[196:199], v38 offset:0
  ds_read_b128 v[200:203], v38 offset:4096
  v_mfma_f32_16x16x32_bf16 v[188:191], v[228:231], v[52:55], v[188:191]
  ds_read_b64_tr_b16 v[224:225], v43 offset:8192
  ds_read_b64_tr_b16 v[226:227], v43 offset:9216
  s_waitcnt lgkmcnt(12)
  v_mfma_f32_32x32x16_bf16 v[88:103], v[232:235], v[204:207], v[88:103]
  v_mfma_f32_32x32x16_bf16 v[116:131], v[232:235], v[208:211], v[116:131]
  v_mfma_f32_16x16x32_bf16 v[192:195], v[232:235], v[52:55], v[192:195]
  s_waitcnt lgkmcnt(9)
  v_mfma_f32_32x32x16_bf16 v[56:71], v[236:239], v[212:215], v[56:71]
  ds_read_b64_tr_b16 v[228:229], v42 offset:12288
  ds_read_b64_tr_b16 v[230:231], v42 offset:13312
  s_waitcnt lgkmcnt(10)
  v_mfma_f32_32x32x16_bf16 v[72:87], v[236:239], v[216:219], v[72:87]
  ds_read_b128 v[204:207], v39 offset:0
  ds_read_b128 v[208:211], v39 offset:4096
  v_mfma_f32_16x16x32_bf16 v[188:191], v[236:239], v[52:55], v[188:191]
  ds_read_b64_tr_b16 v[232:233], v43 offset:12288
  ds_read_b64_tr_b16 v[234:235], v43 offset:13312
  v_mov_b32 v3, EP_G_rel4
  s_mov_b64 exec, 1
  ds_write_b32 v28, v3
  s_mov_b64 exec, -1
  ds_read_b32 v2, v27 offset:16
  s_waitcnt lgkmcnt(14)
  v_mfma_f32_32x32x16_bf16 v[88:103], v[240:243], v[212:215], v[88:103]
  v_mfma_f32_32x32x16_bf16 v[116:131], v[240:243], v[216:219], v[116:131]
  v_mfma_f32_16x16x32_bf16 v[192:195], v[240:243], v[52:55], v[192:195]
  s_waitcnt lgkmcnt(11)
  v_mfma_f32_32x32x16_bf16 v[56:71], v[220:223], v[196:199], v[56:71]
  s_waitcnt lgkmcnt(0)
  v_cmp_gt_u32 vcc, EP_H_c5, v2
  s_nop 0
  s_cbranch_vccnz L_aslow31
L_agot31:
  ds_read_b64_tr_b16 v[236:237], v40 offset:32768
  ds_read_b64_tr_b16 v[238:239], v40 offset:33792
  v_mfma_f32_32x32x16_bf16 v[72:87], v[220:223], v[200:203], v[72:87]
  ds_read_b128 v[212:215], v36 offset:32768
  ds_read_b128 v[216:219], v36 offset:36864
  v_mfma_f32_32x32x16_bf16 v[88:103], v[224:227], v[196:199], v[88:103]
  ds_read_b64_tr_b16 v[240:241], v41 offset:32768
  ds_read_b64_tr_b16 v[242:243], v41 offset:33792
  v_mfma_f32_32x32x16_bf16 v[116:131], v[224:227], v[200:203], v[116:131]
  v_mfma_f32_32x32x16_bf16 v[56:71], v[228:231], v[204:207], v[56:71]
  ds_read_b64_tr_b16 v[220:221], v40 offset:36864
  ds_read_b64_tr_b16 v[222:223], v40 offset:37888
  v_mfma_f32_32x32x16_bf16 v[72:87], v[228:231], v[208:211], v[72:87]
  ds_read_b128 v[196:199], v37 offset:32768
  ds_read_b128 v[200:203], v37 offset:36864
  v_mfma_f32_32x32x16_bf16 v[88:103], v[232:235], v[204:207], v[88:103]
  ds_read_b64_tr_b16 v[224:225], v41 offset:36864
  ds_read_b64_tr_b16 v[226:227], v41 offset:37888
  v_mfma_f32_32x32x16_bf16 v[116:131], v[232:235], v[208:211], v[116:131]
  s_waitcnt lgkmcnt(9)
  v_mfma_f32_32x32x16_bf16 v[56:71], v[236:239], v[212:215], v[56:71]
  ds_read_b64_tr_b16 v[228:229], v42 offset:40960
  ds_read_b64_tr_b16 v[230:231], v42 offset:41984
  s_waitcnt lgkmcnt(10)
  v_mfma_f32_32x32x16_bf16 v[72:87], v[236:239], v[216:219], v[72:87]
  ds_read_b128 v[204:207], v38 offset:32768
  ds_read_b128 v[208:211], v38 offset:36864
  v_mfma_f32_16x16x32_bf16 v[188:191], v[236:239], v[52:55], v[188:191]
  ds_read_b64_tr_b16 v[232:233], v43 offset:40960
  ds_read_b64_tr_b16 v[234:235], v43 offset:41984
  s_waitcnt lgkmcnt(12)
  v_mfma_f32_32x32x16_bf16 v[88:103], v[240:243], v[212:215], v[88:103]
  v_mfma_f32_32x32x16_bf16 v[116:131], v[240:243], v[216:219], v[116:131]
  v_mfma_f32_16x16x32_bf16 v[192:195], v[240:243], v[52:55], v[192:195]
  s_waitcnt lgkmcnt(9)
  v_mfma_f32_32x32x16_bf16 v[56:71], v[220:223], v[196:199], v[56:71]
  ds_read_b64_tr_b16 v[236:237], v42 offset:45056
  ds_read_b64_tr_b16 v[238:239], v42 offset:46080
  s_waitcnt lgkmcnt(10)
  v_mfma_f32_32x32x16_bf16 v[72:87], v[220:223], v[200:203], v[72:87]
  ds_read_b128 v[212:215], v39 offset:32768
  ds_read_b128 v[216:219], v39 offset:36864
  v_mfma_f32_16x16x32_bf16 v[188:191], v[220:223], v[52:55], v[188:191]
  ds_read_b64_tr_b16 v[240:241], v43 offset:45056
  ds_read_b64_tr_b16 v[242:243], v43 offset:46080
  v_mov_b32 v3, EP_G_rel5
  s_mov_b64 exec, 1
  ds_write_b32 v28, v3
  s_mov_b64 exec, -1
  ds_read_b32 v2, v27 offset:16
  s_waitcnt lgkmcnt(14)
  v_mfma_f32_32x32x16_bf16 v[88:103], v[224:227], v[196:199], v[88:103]
  v_mfma_f32_32x32x16_bf16 v[116:131], v[224:227], v[200:203], v[116:131]
  v_mfma_f32_16x16x32_bf16 v[192:195], v[224:227], v[52:55], v[192:195]
  s_waitcnt lgkmcnt(11)
  v_mfma_f32_32x32x16_bf16 v[56:71], v[228:231], v[204:207], v[56:71]
  s_waitcnt lgkmcnt(0)
  v_cmp_gt_u32 vcc, EP_H_c6, v2
  s_nop 0
  s_cbranch_vccnz L_aslow32
L_agot32:
  ds_read_b64_tr_b16 v[220:221], v48 offset:0
  ds_read_b64_tr_b16 v[222:223], v48 offset:1024
  v_mfma_f32_32x32x16_bf16 v[72:87], v[228:231], v[208:211], v[72:87]
  ds_read_b128 v[196:199], v44 offset:0
  ds_read_b128 v[200:203], v44 offset:4096
  v_mfma_f32_32x32x16_bf16 v[88:103], v[232:235], v[204:207], v[88:103]
  ds_read_b64_tr_b16 v[224:225], v49 offset:0
  ds_read_b64_tr_b16 v[226:227], v49 offset:1024
  v_mfma_f32_32x32x16_bf16 v[116:131], v[232:235], v[208:211], v[116:131]
  v_mfma_f32_32x32x16_bf16 v[56:71], v[236:239], v[212:215], v[56:71]
  ds_read_b64_tr_b16 v[228:229], v48 offset:4096
  ds_read_b64_tr_b16 v[230:231], v48 offset:5120
  v_mfma_f32_32x32x16_bf16 v[72:87], v[236:239], v[216:219], v[72:87]
  ds_read_b128 v[204:207], v45 offset:0
  ds_read_b128 v[208:211], v45 offset:4096
  v_mfma_f32_32x32x16_bf16 v[88:103], v[240:243], v[212:215], v[88:103]
  ds_read_b64_tr_b16 v[232:233], v49 offset:4096
  ds_read_b64_tr_b16 v[234:235], v49 offset:5120
  v_mfma_f32_32x32x16_bf16 v[116:131], v[240:243], v[216:219], v[116:131]
  s_waitcnt lgkmcnt(9)
  v_mfma_f32_32x32x16_bf16 v[56:71], v[220:223], v[196:199], v[56:71]
  ds_read_b64_tr_b16 v[236:237], v50 offset:8192
  ds_read_b64_tr_b16 v[238:239], v50 offset:9216
  s_waitcnt lgkmcnt(10)
  v_mfma_f32_32x32x16_bf16 v[72:87], v[220:223], v[200:203], v[72:87]
  ds_read_b128 v[212:215], v46 offset:0
  ds_read_b128 v[216:219], v46 offset:4096
  v_mfma_f32_16x16x32_bf16 v[188:191], v[220:223], v[52:55], v[188:191]
  ds_read_b64_tr_b16 v[240:241], v51 offset:8192
  ds_read_b64_tr_b16 v[242:243], v51 offset:9216
  s_waitcnt lgkmcnt(12)
  v_mfma_f32_32x32x16_bf16 v[88:103], v[224:227], v[196:199], v[88:103]
  v_mfma_f32_32x32x16_bf16 v[116:131], v[224:227], v[200:203], v[116:131]
  v_mfma_f32_16x16x32_bf16 v[192:195], v[224:227], v[52:55], v[192:195]
  s_waitcnt lgkmcnt(9)
  v_mfma_f32_32x32x16_bf16 v[56:71], v[228:231], v[204:207], v[56:71]
  ds_read_b64_tr_b16 v[220:221], v50 offset:12288
  ds_read_b64_tr_b16 v[222:223], v50 offset:13312
  s_waitcnt lgkmcnt(10)
  v_mfma_f32_32x32x16_bf16 v[72:87], v[228:231], v[208:211], v[72:87]
  ds_read_b128 v[196:199], v47 offset:0
  ds_read_b128 v[200:203], v47 offset:4096
  v_mfma_f32_16x16x32_bf16 v[188:191], v[228:231], v[52:55], v[188:191]
  ds_read_b64_tr_b16 v[224:225], v51 offset:12288
  ds_read_b64_tr_b16 v[226:227], v51 offset:13312
  v_mov_b32 v3, EP_G_rel6
  s_mov_b64 exec, 1
  ds_write_b32 v28, v3
  s_mov_b64 exec, -1
  ds_read_b32 v2, v27 offset:16
  s_waitcnt lgkmcnt(14)
  v_mfma_f32_32x32x16_bf16 v[88:103], v[232:235], v[204:207], v[88:103]
  v_mfma_f32_32x32x16_bf16 v[116:131], v[232:235], v[208:211], v[116:131]
  v_mfma_f32_16x16x32_bf16 v[192:195], v[232:235], v[52:55], v[192:195]
  s_waitcnt lgkmcnt(11)
  v_mfma_f32_32x32x16_bf16 v[56:71], v[236:239], v[212:215], v[56:71]
  s_waitcnt lgkmcnt(0)
  v_cmp_gt_u32 vcc, EP_H_c7, v2
  s_nop 0
  s_cbranch_vccnz L_aslow33
L_agot33:
  ds_read_b64_tr_b16 v[228:229], v48 offset:32768
  ds_read_b64_tr_b16 v[230:231], v48 offset:33792
  v_mfma_f32_32x32x16_bf16 v[72:87], v[236:239], v[216:219], v[72:87]
  ds_read_b128 v[204:207], v44 offset:32768
  ds_read_b128 v[208:211], v44 offset:36864
  v_mfma_f32_32x32x16_bf16 v[88:103], v[240:243], v[212:215], v[88:103]
  ds_read_b64_tr_b16 v[232:233], v49 offset:32768
  ds_read_b64_tr_b16 v[234:235], v49 offset:33792
  v_mfma_f32_32x32x16_bf16 v[116:131], v[240:243], v[216:219], v[116:131]
  v_mfma_f32_32x32x16_bf16 v[56:71], v[220:223], v[196:199], v[56:71]
  ds_read_b64_tr_b16 v[236:237], v48 offset:36864
  ds_read_b64_tr_b16 v[238:239], v48 offset:37888
  v_mfma_f32_32x32x16_bf16 v[72:87], v[220:223], v[200:203], v[72:87]
  ds_read_b128 v[212:215], v45 offset:32768
  ds_read_b128 v[216:219], v45 offset:36864
  v_mfma_f32_32x32x16_bf16 v[88:103], v[224:227], v[196:199], v[88:103]
  ds_read_b64_tr_b16 v[240:241], v49 offset:36864
  ds_read_b64_tr_b16 v[242:243], v49 offset:37888
  v_mfma_f32_32x32x16_bf16 v[116:131], v[224:227], v[200:203], v[116:131]
  s_waitcnt lgkmcnt(9)
  v_mfma_f32_32x32x16_bf16 v[56:71], v[228:231], v[204:207], v[56:71]
  ds_read_b64_tr_b16 v[220:221], v50 offset:40960
  ds_read_b64_tr_b16 v[222:223], v50 offset:41984
  s_waitcnt lgkmcnt(10)
  v_mfma_f32_32x32x16_bf16 v[72:87], v[228:231], v[208:211], v[72:87]
  ds_read_b128 v[196:199], v46 offset:32768
  ds_read_b128 v[200:203], v46 offset:36864
  v_mfma_f32_16x16x32_bf16 v[188:191], v[228:231], v[52:55], v[188:191]
  ds_read_b64_tr_b16 v[224:225], v51 offset:40960
  ds_read_b64_tr_b16 v[226:227], v51 offset:41984
  s_waitcnt lgkmcnt(12)
  v_mfma_f32_32x32x16_bf16 v[88:103], v[232:235], v[204:207], v[88:103]
  v_mfma_f32_32x32x16_bf16 v[116:131], v[232:235], v[208:211], v[116:131]
  v_mfma_f32_16x16x32_bf16 v[192:195], v[232:235], v[52:55], v[192:195]
  s_waitcnt lgkmcnt(9)
  v_mfma_f32_32x32x16_bf16 v[56:71], v[236:239], v[212:215], v[56:71]
  ds_read_b64_tr_b16 v[228:229], v50 offset:45056
  ds_read_b64_tr_b16 v[230:231], v50 offset:46080
  s_waitcnt lgkmcnt(10)
  v_mfma_f32_32x32x16_bf16 v[72:87], v[236:239], v[216:219], v[72:87]
  ds_read_b128 v[204:207], v47 offset:32768
  ds_read_b128 v[208:211], v47 offset:36864
  v_mfma_f32_16x16x32_bf16 v[188:191], v[236:239], v[52:55], v[188:191]
  ds_read_b64_tr_b16 v[232:233], v51 offset:45056
  ds_read_b64_tr_b16 v[234:235], v51 offset:46080
  s_waitcnt lgkmcnt(12)
  v_mfma_f32_32x32x16_bf16 v[88:103], v[240:243], v[212:215], v[88:103]
  v_mfma_f32_32x32x16_bf16 v[116:131], v[240:243], v[216:219], v[116:131]
  v_mfma_f32_16x16x32_bf16 v[192:195], v[240:243], v[52:55], v[192:195]
  s_waitcnt lgkmcnt(9)
  v_mfma_f32_32x32x16_bf16 v[56:71], v[220:223], v[196:199], v[56:71]
  s_waitcnt lgkmcnt(8)
  v_mfma_f32_32x32x16_bf16 v[72:87], v[220:223], v[200:203], v[72:87]
  s_waitcnt lgkmcnt(6)
  v_mfma_f32_32x32x16_bf16 v[88:103], v[224:227], v[196:199], v[88:103]
  s_mov_b32 exec_lo, 0x00030003
  s_mov_b32 exec_hi, 0x00030003
  ds_write_b128 v112, v[188:191] offset:0
  ds_write_b128 v112, v[192:195] offset:128
  s_mov_b64 exec, -1
  v_mov_b32 v3, EP_G_cs
  s_mov_b64 exec, 1
  ds_write_b32 v28, v3
  s_mov_b64 exec, -1
  ds_read_b32 v248, v244 offset:0
  ds_read_b32 v250, v244 offset:128
  ds_read_b32 v249, v244 offset:1024
  ds_read_b32 v2, v27 offset:0
  v_mfma_f32_32x32x16_bf16 v[116:131], v[224:227], v[200:203], v[116:131]
  s_waitcnt lgkmcnt(10)
  v_mfma_f32_32x32x16_bf16 v[56:71], v[228:231], v[204:207], v[56:71]
  s_waitcnt lgkmcnt(9)
  v_mfma_f32_32x32x16_bf16 v[72:87], v[228:231], v[208:211], v[72:87]
  s_waitcnt lgkmcnt(7)
  v_mfma_f32_32x32x16_bf16 v[88:103], v[232:235], v[204:207], v[88:103]
  s_waitcnt lgkmcnt(0)
  v_cmp_gt_u32 vcc, EP_G_cs, v2
  s_nop 0
  s_cbranch_vccnz L_aslow34
L_agot34:
  ds_read_b128 v[104:107], v113 offset:0
  ds_read_b128 v[156:159], v113 offset:256
  ds_read_b128 v[108:111], v113 offset:32
  ds_read_b128 v[160:163], v113 offset:288
  ds_read_b128 v[132:135], v113 offset:64
  ds_read_b128 v[164:167], v113 offset:320
  ds_read_b128 v[136:139], v113 offset:96
  ds_read_b128 v[168:171], v113 offset:352
  ds_read_b128 v[140:143], v113 offset:128
  ds_read_b128 v[172:175], v113 offset:384
  ds_read_b128 v[144:147], v113 offset:160
  ds_read_b128 v[176:179], v113 offset:416
  ds_read_b128 v[148:151], v113 offset:192
  ds_read_b128 v[180:183], v113 offset:448
  ds_read_b128 v[152:155], v113 offset:224
  ds_read_b128 v[184:187], v113 offset:480
  v_mfma_f32_32x32x16_bf16 v[116:131], v[232:235], v[208:211], v[116:131]
  s_setprio 3
  s_add_u32 s45, s60, 4096
  v_readfirstlane_b32 s6, v249
  s_waitcnt lgkmcnt(14)
  v_pk_add_f32 v[104:105], v[104:105], v[156:157]
  v_pk_add_f32 v[106:107], v[106:107], v[158:159]
  s_waitcnt lgkmcnt(12)
  v_pk_add_f32 v[108:109], v[108:109], v[160:161]
  v_pk_add_f32 v[110:111], v[110:111], v[162:163]
  v_pk_fma_f32 v[56:57], v[104:105], v[248:249], v[56:57] op_sel_hi:[1,0,1] neg_lo:[1,0,0] neg_hi:[1,0,0]
  v_pk_fma_f32 v[58:59], v[106:107], v[248:249], v[58:59] op_sel_hi:[1,0,1] neg_lo:[1,0,0] neg_hi:[1,0,0]
  v_pk_fma_f32 v[60:61], v[108:109], v[248:249], v[60:61] op_sel_hi:[1,0,1] neg_lo:[1,0,0] neg_hi:[1,0,0]
  v_pk_fma_f32 v[62:63], v[110:111], v[248:249], v[62:63] op_sel_hi:[1,0,1] neg_lo:[1,0,0] neg_hi:[1,0,0]
  v_pk_fma_f32 v[72:73], v[104:105], v[250:251], v[72:73] op_sel_hi:[1,0,1] neg_lo:[1,0,0] neg_hi:[1,0,0]
  v_pk_fma_f32 v[74:75], v[106:107], v[250:251], v[74:75] op_sel_hi:[1,0,1] neg_lo:[1,0,0] neg_hi:[1,0,0]
  v_pk_fma_f32 v[76:77], v[108:109], v[250:251], v[76:77] op_sel_hi:[1,0,1] neg_lo:[1,0,0] neg_hi:[1,0,0]
  v_pk_fma_f32 v[78:79], v[110:111], v[250:251], v[78:79] op_sel_hi:[1,0,1] neg_lo:[1,0,0] neg_hi:[1,0,0]
  v_cvt_pk_bf16_f32 v156, v56, v57
  v_cvt_pk_bf16_f32 v157, v58, v59
  v_cvt_pk_bf16_f32 v158, v60, v61
  v_cvt_pk_bf16_f32 v159, v62, v63
  v_pk_max_i16 v156, v156, 0
  v_pk_max_i16 v157, v157, 0
  v_pk_max_i16 v158, v158, 0
  v_pk_max_i16 v159, v159, 0
  v_cvt_pk_bf16_f32 v160, v72, v73
  v_cvt_pk_bf16_f32 v161, v74, v75
  v_cvt_pk_bf16_f32 v162, v76, v77
  v_cvt_pk_bf16_f32 v163, v78, v79
  v_pk_max_i16 v160, v160, 0
  v_pk_max_i16 v161, v161, 0
  v_pk_max_i16 v162, v162, 0
  v_pk_max_i16 v163, v163, 0
  buffer_store_dwordx4 v[156:159], v18, s[32:35], s60 offen offset:0 sc1
  buffer_store_dwordx4 v[160:163], v18, s[32:35], s60 offen offset:1024 sc1
  s_waitcnt lgkmcnt(10)
  v_pk_add_f32 v[132:133], v[132:133], v[164:165]
  v_pk_add_f32 v[134:135], v[134:135], v[166:167]
  s_waitcnt lgkmcnt(8)
  v_pk_add_f32 v[136:137], v[136:137], v[168:169]
  v_pk_add_f32 v[138:139], v[138:139], v[170:171]
  v_pk_fma_f32 v[64:65], v[132:133], v[248:249], v[64:65] op_sel_hi:[1,0,1] neg_lo:[1,0,0] neg_hi:[1,0,0]
  v_pk_fma_f32 v[66:67], v[134:135], v[248:249], v[66:67] op_sel_hi:[1,0,1] neg_lo:[1,0,0] neg_hi:[1,0,0]
  v_pk_fma_f32 v[68:69], v[136:137], v[248:249], v[68:69] op_sel_hi:[1,0,1] neg_lo:[1,0,0] neg_hi:[1,0,0]
  v_pk_fma_f32 v[70:71], v[138:139], v[248:249], v[70:71] op_sel_hi:[1,0,1] neg_lo:[1,0,0] neg_hi:[1,0,0]
  v_pk_fma_f32 v[80:81], v[132:133], v[250:251], v[80:81] op_sel_hi:[1,0,1] neg_lo:[1,0,0] neg_hi:[1,0,0]
  v_pk_fma_f32 v[82:83], v[134:135], v[250:251], v[82:83] op_sel_hi:[1,0,1] neg_lo:[1,0,0] neg_hi:[1,0,0]
  v_pk_fma_f32 v[84:85], v[136:137], v[250:251], v[84:85] op_sel_hi:[1,0,1] neg_lo:[1,0,0] neg_hi:[1,0,0]
  v_pk_fma_f32 v[86:87], v[138:139], v[250:251], v[86:87] op_sel_hi:[1,0,1] neg_lo:[1,0,0] neg_hi:[1,0,0]
  v_cvt_pk_bf16_f32 v164, v64, v65
  v_cvt_pk_bf16_f32 v165, v66, v67
  v_cvt_pk_bf16_f32 v166, v68, v69
  v_cvt_pk_bf16_f32 v167, v70, v71
  v_pk_max_i16 v164, v164, 0
  v_pk_max_i16 v165, v165, 0
  v_pk_max_i16 v166, v166, 0
  v_pk_max_i16 v167, v167, 0
  v_cvt_pk_bf16_f32 v168, v80, v81
  v_cvt_pk_bf16_f32 v169, v82, v83
  v_cvt_pk_bf16_f32 v170, v84, v85
  v_cvt_pk_bf16_f32 v171, v86, v87
  v_pk_max_i16 v168, v168, 0
  v_pk_max_i16 v169, v169, 0
  v_pk_max_i16 v170, v170, 0
  v_pk_max_i16 v171, v171, 0
  buffer_store_dwordx4 v[164:167], v18, s[32:35], s60 offen offset:2048 sc1
  buffer_store_dwordx4 v[168:171], v18, s[32:35], s60 offen offset:3072 sc1
  s_waitcnt lgkmcnt(6)
  v_pk_add_f32 v[140:141], v[140:141], v[172:173]
  v_pk_add_f32 v[142:143], v[142:143], v[174:175]
  s_waitcnt lgkmcnt(4)
  v_pk_add_f32 v[144:145], v[144:145], v[176:177]
  v_pk_add_f32 v[146:147], v[146:147], v[178:179]
  v_pk_fma_f32 v[88:89], v[140:141], v[248:249], v[88:89] op_sel_hi:[1,0,1] neg_lo:[1,0,0] neg_hi:[1,0,0]
  v_pk_fma_f32 v[90:91], v[142:143], v[248:249], v[90:91] op_sel_hi:[1,0,1] neg_lo:[1,0,0] neg_hi:[1,0,0]
  v_pk_fma_f32 v[92:93], v[144:145], v[248:249], v[92:93] op_sel_hi:[1,0,1] neg_lo:[1,0,0] neg_hi:[1,0,0]
  v_pk_fma_f32 v[94:95], v[146:147], v[248:249], v[94:95] op_sel_hi:[1,0,1] neg_lo:[1,0,0] neg_hi:[1,0,0]
  v_pk_fma_f32 v[116:117], v[140:141], v[250:251], v[116:117] op_sel_hi:[1,0,1] neg_lo:[1,0,0] neg_hi:[1,0,0]
  v_pk_fma_f32 v[118:119], v[142:143], v[250:251], v[118:119] op_sel_hi:[1,0,1] neg_lo:[1,0,0] neg_hi:[1,0,0]
  v_pk_fma_f32 v[120:121], v[144:145], v[250:251], v[120:121] op_sel_hi:[1,0,1] neg_lo:[1,0,0] neg_hi:[1,0,0]
  v_pk_fma_f32 v[122:123], v[146:147], v[250:251], v[122:123] op_sel_hi:[1,0,1] neg_lo:[1,0,0] neg_hi:[1,0,0]
  v_cvt_pk_bf16_f32 v172, v88, v89
  v_cvt_pk_bf16_f32 v173, v90, v91
  v_cvt_pk_bf16_f32 v174, v92, v93
  v_cvt_pk_bf16_f32 v175, v94, v95
  v_pk_max_i16 v172, v172, 0
  v_pk_max_i16 v173, v173, 0
  v_pk_max_i16 v174, v174, 0
  v_pk_max_i16 v175, v175, 0
  v_cvt_pk_bf16_f32 v176, v116, v117
  v_cvt_pk_bf16_f32 v177, v118, v119
  v_cvt_pk_bf16_f32 v178, v120, v121
  v_cvt_pk_bf16_f32 v179, v122, v123
  v_pk_max_i16 v176, v176, 0
  v_pk_max_i16 v177, v177, 0
  v_pk_max_i16 v178, v178, 0
  v_pk_max_i16 v179, v179, 0
  buffer_store_dwordx4 v[172:175], v18, s[32:35], s45 offen offset:0 sc1
  buffer_store_dwordx4 v[176:179], v18, s[32:35], s45 offen offset:1024 sc1
  s_waitcnt lgkmcnt(2)
  v_pk_add_f32 v[148:149], v[148:149], v[180:181]
  v_pk_add_f32 v[150:151], v[150:151], v[182:183]
  s_waitcnt lgkmcnt(0)
  v_pk_add_f32 v[152:153], v[152:153], v[184:185]
  v_pk_add_f32 v[154:155], v[154:155], v[186:187]
  v_pk_fma_f32 v[96:97], v[148:149], v[248:249], v[96:97] op_sel_hi:[1,0,1] neg_lo:[1,0,0] neg_hi:[1,0,0]
  v_pk_fma_f32 v[98:99], v[150:151], v[248:249], v[98:99] op_sel_hi:[1,0,1] neg_lo:[1,0,0] neg_hi:[1,0,0]
  v_pk_fma_f32 v[100:101], v[152:153], v[248:249], v[100:101] op_sel_hi:[1,0,1] neg_lo:[1,0,0] neg_hi:[1,0,0]
  v_pk_fma_f32 v[102:103], v[154:155], v[248:249], v[102:103] op_sel_hi:[1,0,1] neg_lo:[1,0,0] neg_hi:[1,0,0]
  v_pk_fma_f32 v[124:125], v[148:149], v[250:251], v[124:125] op_sel_hi:[1,0,1] neg_lo:[1,0,0] neg_hi:[1,0,0]
  v_pk_fma_f32 v[126:127], v[150:151], v[250:251], v[126:127] op_sel_hi:[1,0,1] neg_lo:[1,0,0] neg_hi:[1,0,0]
  v_pk_fma_f32 v[128:129], v[152:153], v[250:251], v[128:129] op_sel_hi:[1,0,1] neg_lo:[1,0,0] neg_hi:[1,0,0]
  v_pk_fma_f32 v[130:131], v[154:155], v[250:251], v[130:131] op_sel_hi:[1,0,1] neg_lo:[1,0,0] neg_hi:[1,0,0]
  v_cvt_pk_bf16_f32 v180, v96, v97
  v_cvt_pk_bf16_f32 v181, v98, v99
  v_cvt_pk_bf16_f32 v182, v100, v101
  v_cvt_pk_bf16_f32 v183, v102, v103
  v_pk_max_i16 v180, v180, 0
  v_pk_max_i16 v181, v181, 0
  v_pk_max_i16 v182, v182, 0
  v_pk_max_i16 v183, v183, 0
  v_cvt_pk_bf16_f32 v184, v124, v125
  v_cvt_pk_bf16_f32 v185, v126, v127
  v_cvt_pk_bf16_f32 v186, v128, v129
  v_cvt_pk_bf16_f32 v187, v130, v131
  v_pk_max_i16 v184, v184, 0
  v_pk_max_i16 v185, v185, 0
  v_pk_max_i16 v186, v186, 0
  v_pk_max_i16 v187, v187, 0
  buffer_store_dwordx4 v[180:183], v18, s[32:35], s45 offen offset:2048 sc1
  buffer_store_dwordx4 v[184:187], v18, s[32:35], s45 offen offset:3072 sc1
  s_nop 1
L_join:
  s_add_u32 s52, s20, 3
  s_sub_u32 m0, s52, 7
  s_cmp_ge_u32 s52, 7
  s_cselect_b32 s52, m0, s52
  s_lshl_b32 s52, s52, 16
  s_add_u32 s52, s52, s7
  s_add_u32 m0, s62, 98304
  s_nop 0
  buffer_load_dwordx4 v12, s[24:27], s52 offen offset:0 lds
  buffer_load_dwordx4 v13, s[24:27], s52 offen offset:1024 lds
  buffer_load_dwordx4 v14, s[24:27], s52 offen offset:2048 lds
  buffer_load_dwordx4 v15, s[24:27], s52 offen offset:3072 lds
  s_add_u32 s52, s52, 32768
  s_add_u32 m0, s62, 102400
  s_nop 0
  buffer_load_dwordx4 v12, s[24:27], s52 offen offset:0 lds
  buffer_load_dwordx4 v13, s[24:27], s52 offen offset:1024 lds
  buffer_load_dwordx4 v14, s[24:27], s52 offen offset:2048 lds
  buffer_load_dwordx4 v15, s[24:27], s52 offen offset:3072 lds
  s_waitcnt vmcnt(8)
  s_mov_b64 exec, 1
  s_cmp_lg_u32 s6, 0
  s_cbranch_scc1 L_fm45
  buffer_store_dword v20, v19, s[32:35], s5 offen
L_fmd45:
  s_mov_b64 exec, -1
  s_setprio 0
  ds_read_b32 v2, v27 offset:16
  s_waitcnt lgkmcnt(0)
  v_cmp_gt_u32 vcc, EP_H_xc, v2
  s_nop 0
  s_cbranch_vccnz L_aslow46
L_agot46:
  ds_read_b64_tr_b16 v[36:37], v32 offset:0
  ds_read_b64_tr_b16 v[38:39], v32 offset:1024
  ds_read_b64_tr_b16 v[40:41], v33 offset:0
  ds_read_b64_tr_b16 v[42:43], v33 offset:1024
  ds_read_b64_tr_b16 v[44:45], v32 offset:2048
  ds_read_b64_tr_b16 v[46:47], v32 offset:3072
  ds_read_b64_tr_b16 v[48:49], v33 offset:2048
  ds_read_b64_tr_b16 v[50:51], v33 offset:3072
  ds_read_b64_tr_b16 v[52:53], v32 offset:4096
  ds_read_b64_tr_b16 v[54:55], v32 offset:5120
  ds_read_b64_tr_b16 v[104:105], v33 offset:4096
  ds_read_b64_tr_b16 v[106:107], v33 offset:5120
  ds_read_b64_tr_b16 v[108:109], v32 offset:6144
  ds_read_b64_tr_b16 v[110:111], v32 offset:7168
  ds_read_b64_tr_b16 v[112:113], v33 offset:6144
  ds_read_b64_tr_b16 v[114:115], v33 offset:7168
  ds_read_b64_tr_b16 v[132:133], v32 offset:32768
  ds_read_b64_tr_b16 v[134:135], v32 offset:33792
  ds_read_b64_tr_b16 v[136:137], v33 offset:32768
  ds_read_b64_tr_b16 v[138:139], v33 offset:33792
  ds_read_b64_tr_b16 v[140:141], v32 offset:34816
  ds_read_b64_tr_b16 v[142:143], v32 offset:35840
  ds_read_b64_tr_b16 v[144:145], v33 offset:34816
  ds_read_b64_tr_b16 v[146:147], v33 offset:35840
  ds_read_b64_tr_b16 v[148:149], v32 offset:36864
  ds_read_b64_tr_b16 v[150:151], v32 offset:37888
  ds_read_b64_tr_b16 v[152:153], v33 offset:36864
  ds_read_b64_tr_b16 v[154:155], v33 offset:37888
  ds_read_b64_tr_b16 v[156:157], v32 offset:38912
  ds_read_b64_tr_b16 v[158:159], v32 offset:39936
  ds_read_b64_tr_b16 v[160:161], v33 offset:38912
  ds_read_b64_tr_b16 v[162:163], v33 offset:39936
  s_waitcnt lgkmcnt(15)
  s_add_u32 s52, s20, 4
  s_sub_u32 m0, s52, 7
  s_cmp_ge_u32 s52, 7
  s_cselect_b32 s52, m0, s52
  s_lshl_b32 s52, s52, 16
  s_add_u32 s52, s52, s7
  s_add_u32 m0, s62, 0
  s_nop 0
  buffer_load_dwordx4 v12, s[24:27], s52 offen offset:0 lds
  buffer_load_dwordx4 v13, s[24:27], s52 offen offset:1024 lds
  buffer_load_dwordx4 v14, s[24:27], s52 offen offset:2048 lds
  buffer_load_dwordx4 v15, s[24:27], s52 offen offset:3072 lds
  s_add_u32 s52, s52, 32768
  s_add_u32 m0, s62, 4096
  s_nop 0
  buffer_load_dwordx4 v12, s[24:27], s52 offen offset:0 lds
  buffer_load_dwordx4 v13, s[24:27], s52 offen offset:1024 lds
  buffer_load_dwordx4 v14, s[24:27], s52 offen offset:2048 lds
  buffer_load_dwordx4 v15, s[24:27], s52 offen offset:3072 lds
  ds_read_b32 v2, v27 offset:16
  s_waitcnt lgkmcnt(0)
  v_cmp_gt_u32 vcc, EP_H_w2, v2
  s_nop 0
  s_cbranch_vccnz L_aslow47
L_agot47:
  ds_read_b64_tr_b16 v[164:165], v34 offset:0
  ds_read_b64_tr_b16 v[166:167], v34 offset:1024
  ds_read_b64_tr_b16 v[168:169], v35 offset:0
  ds_read_b64_tr_b16 v[170:171], v35 offset:1024
  ds_read_b64_tr_b16 v[172:173], v34 offset:2048
  ds_read_b64_tr_b16 v[174:175], v34 offset:3072
  ds_read_b64_tr_b16 v[176:177], v35 offset:2048
  ds_read_b64_tr_b16 v[178:179], v35 offset:3072
  ds_read_b64_tr_b16 v[180:181], v34 offset:4096
  ds_read_b64_tr_b16 v[182:183], v34 offset:5120
  ds_read_b64_tr_b16 v[184:185], v35 offset:4096
  ds_read_b64_tr_b16 v[186:187], v35 offset:5120
  ds_read_b64_tr_b16 v[188:189], v34 offset:6144
  ds_read_b64_tr_b16 v[190:191], v34 offset:7168
  ds_read_b64_tr_b16 v[192:193], v35 offset:6144
  ds_read_b64_tr_b16 v[194:195], v35 offset:7168
  s_add_u32 s52, s20, 5
  s_sub_u32 m0, s52, 7
  s_cmp_ge_u32 s52, 7
  s_cselect_b32 s52, m0, s52
  s_lshl_b32 s52, s52, 16
  s_add_u32 s52, s52, s7
  s_add_u32 m0, s62, 32768
  s_nop 0
  buffer_load_dwordx4 v12, s[24:27], s52 offen offset:0 lds
  buffer_load_dwordx4 v13, s[24:27], s52 offen offset:1024 lds
  buffer_load_dwordx4 v14, s[24:27], s52 offen offset:2048 lds
  buffer_load_dwordx4 v15, s[24:27], s52 offen offset:3072 lds
  s_add_u32 s52, s52, 32768
  s_add_u32 m0, s62, 36864
  s_nop 0
  buffer_load_dwordx4 v12, s[24:27], s52 offen offset:0 lds
  buffer_load_dwordx4 v13, s[24:27], s52 offen offset:1024 lds
  buffer_load_dwordx4 v14, s[24:27], s52 offen offset:2048 lds
  buffer_load_dwordx4 v15, s[24:27], s52 offen offset:3072 lds
  s_lshl_b32 s23, s36, 2
  s_add_u32 s23, s23, s42
  s_lshl_b32 s44, s23, 9
  s_mul_i32 s45, s38, 112
  s_add_u32 s44, s44, s45
  s_add_u32 s44, s44, 36864
  v_min_u32 v16, 6, v1
  v_lshlrev_b32 v16, 4, v16
  v_add_u32 v16, s44, v16
  s_and_b32 s58, s38, 1
  s_lshr_b32 s59, s38, 1
  v_lshlrev_b32 v4, 5, v21
  v_and_b32 v5, 1, v17
  v_lshl_add_u32 v4, v5, 4, v4
  v_add_u32 v4, v4, v23
  v_lshlrev_b32 v5, 4, v26
  v_lshl_add_u32 v30, v4, 10, v5
  v_add_u32 v31, 64512, v30
  s_lshl_b32 s54, s36, 8
  s_lshl_b32 s44, s59, 7
  s_add_u32 s54, s54, s44
  s_lshl_b32 s44, s42, 2
  s_add_u32 s54, s54, s44
  s_lshl_b32 s47, s54, 3
  s_add_u32 s47, s47, 98304
  s_lshl_b32 s54, s54, 10
  s_lshl_b32 s44, s41, 7
  s_add_u32 s54, s54, s44
  s_lshl_b32 s44, s58, 6
  s_add_u32 s54, s54, s44
  s_lshl_b32 s44, s59, 10
  v_add_u32 v23, s44, v18
  v_xor_b32 v26, 0x400, v23
  s_mul_i32 s60, s23, 229376
  s_mul_i32 s44, s38, 57344
  s_add_u32 s60, s60, s44
  s_add_u32 s60, s60, 8388608
  v_lshlrev_b32 v25, 3, v25
  s_waitcnt lgkmcnt(0)
  buffer_load_dword v24, v16, s[32:35], 0 offen sc1
  s_add_u32 s52, s20, 6
  s_sub_u32 m0, s52, 7
  s_cmp_ge_u32 s52, 7
  s_cselect_b32 s52, m0, s52
  s_lshl_b32 s52, s52, 16
  s_add_u32 s52, s52, s7
  s_add_u32 m0, s62, 65536
  s_nop 0
  buffer_load_dwordx4 v12, s[24:27], s52 offen offset:0 lds
  buffer_load_dwordx4 v13, s[24:27], s52 offen offset:1024 lds
  buffer_load_dwordx4 v14, s[24:27], s52 offen offset:2048 lds
  buffer_load_dwordx4 v15, s[24:27], s52 offen offset:3072 lds
  s_add_u32 s52, s52, 32768
  s_add_u32 m0, s62, 69632
  s_nop 0
  buffer_load_dwordx4 v12, s[24:27], s52 offen offset:0 lds
  buffer_load_dwordx4 v13, s[24:27], s52 offen offset:1024 lds
  buffer_load_dwordx4 v14, s[24:27], s52 offen offset:2048 lds
  buffer_load_dwordx4 v15, s[24:27], s52 offen offset:3072 lds
  s_waitcnt vmcnt(8)
  v_cmp_ne_u32 vcc, s39, v24
  s_nop 0
  s_cbranch_vccnz L_slow48
L_got48:
  s_mov_b32 s63, s20
  s_lshl_b32 s63, s63, 13
  s_add_u32 s63, s63, s60
  buffer_load_dwordx4 v[220:223], v23, s[32:35], s63 offen offset:0 sc1
  buffer_load_dwordx4 v[224:227], v26, s[32:35], s63 offen offset:0 sc1
  buffer_load_dwordx4 v[228:231], v23, s[32:35], s63 offen offset:2048 sc1
  buffer_load_dwordx4 v[232:235], v26, s[32:35], s63 offen offset:2048 sc1
  s_add_u32 s63, s63, 4096
  buffer_load_dwordx4 v[236:239], v23, s[32:35], s63 offen offset:0 sc1
  buffer_load_dwordx4 v[240:243], v26, s[32:35], s63 offen offset:0 sc1
  buffer_load_dwordx4 v[244:247], v23, s[32:35], s63 offen offset:2048 sc1
  buffer_load_dwordx4 v[248:251], v26, s[32:35], s63 offen offset:2048 sc1
  buffer_load_dword v29, v25, s[32:35], s47 offen sc1
  s_waitcnt vmcnt(8)
  v_mfma_f32_32x32x16_bf16 v[56:71], v[36:39], v[220:223], 0
  v_mfma_f32_32x32x16_bf16 v[88:103], v[40:43], v[220:223], 0
  s_waitcnt vmcnt(7)
  v_mfma_f32_32x32x16_bf16 v[72:87], v[36:39], v[224:227], 0
  v_mfma_f32_32x32x16_bf16 v[116:131], v[40:43], v[224:227], 0
  s_waitcnt vmcnt(6)
  v_mfma_f32_32x32x16_bf16 v[56:71], v[44:47], v[228:231], v[56:71]
  s_add_u32 s63, s20, 3
  s_sub_u32 s56, s63, 7
  s_cmp_ge_u32 s63, 7
  s_cselect_b32 s63, s56, s63
  s_lshl_b32 s63, s63, 13
  s_add_u32 s63, s63, s60
  buffer_load_dwordx4 v[220:223], v23, s[32:35], s63 offen offset:0 sc1
  buffer_load_dwordx4 v[224:227], v26, s[32:35], s63 offen offset:0 sc1
  buffer_load_dwordx4 v[36:39], v23, s[32:35], s63 offen offset:2048 sc1
  buffer_load_dwordx4 v[40:43], v26, s[32:35], s63 offen offset:2048 sc1
  v_mfma_f32_32x32x16_bf16 v[88:103], v[48:51], v[228:231], v[88:103]
  s_waitcnt vmcnt(9)
  v_mfma_f32_32x32x16_bf16 v[72:87], v[44:47], v[232:235], v[72:87]
  v_mfma_f32_32x32x16_bf16 v[116:131], v[48:51], v[232:235], v[116:131]
  s_waitcnt vmcnt(8)
  v_mfma_f32_32x32x16_bf16 v[56:71], v[52:55], v[236:239], v[56:71]
  ds_read_b64_tr_b16 v[204:205], v34 offset:32768
  s_add_u32 s63, s63, 4096
  buffer_load_dwordx4 v[228:231], v23, s[32:35], s63 offen offset:0 sc1
  buffer_load_dwordx4 v[232:235], v26, s[32:35], s63 offen offset:0 sc1
  buffer_load_dwordx4 v[44:47], v23, s[32:35], s63 offen offset:2048 sc1
  buffer_load_dwordx4 v[48:51], v26, s[32:35], s63 offen offset:2048 sc1
  v_mfma_f32_32x32x16_bf16 v[88:103], v[104:107], v[236:239], v[88:103]
  ds_read_b64_tr_b16 v[206:207], v34 offset:33792
  s_waitcnt vmcnt(11)
  v_mfma_f32_32x32x16_bf16 v[72:87], v[52:55], v[240:243], v[72:87]
  ds_read_b64_tr_b16 v[208:209], v35 offset:32768
  v_mfma_f32_32x32x16_bf16 v[116:131], v[104:107], v[240:243], v[116:131]
  ds_read_b64_tr_b16 v[210:211], v35 offset:33792
  s_waitcnt vmcnt(10)
  v_mfma_f32_32x32x16_bf16 v[56:71], v[108:111], v[244:247], v[56:71]
  ds_read_b64_tr_b16 v[212:213], v34 offset:34816
  s_add_u32 s63, s20, 6
  s_sub_u32 s56, s63, 7
  s_cmp_ge_u32 s63, 7
  s_cselect_b32 s63, s56, s63
  s_lshl_b32 s63, s63, 13
  s_add_u32 s63, s63, s60
  buffer_load_dwordx4 v[236:239], v23, s[32:35], s63 offen offset:0 sc1
  buffer_load_dwordx4 v[240:243], v26, s[32:35], s63 offen offset:0 sc1
  buffer_load_dwordx4 v[52:55], v23, s[32:35], s63 offen offset:2048 sc1
  buffer_load_dwordx4 v[104:107], v26, s[32:35], s63 offen offset:2048 sc1
  v_mfma_f32_32x32x16_bf16 v[88:103], v[112:115], v[244:247], v[88:103]
  ds_read_b64_tr_b16 v[214:215], v34 offset:35840
  s_waitcnt vmcnt(13)
  v_mfma_f32_32x32x16_bf16 v[72:87], v[108:111], v[248:251], v[72:87]
  ds_read_b64_tr_b16 v[216:217], v35 offset:34816
  v_mfma_f32_32x32x16_bf16 v[116:131], v[112:115], v[248:251], v[116:131]
  ds_read_b64_tr_b16 v[218:219], v35 offset:35840
  s_waitcnt vmcnt(11) lgkmcnt(6)
  v_mfma_f32_32x32x16_bf16 v[56:71], v[204:207], v[220:223], v[56:71]
  ds_read_b64_tr_b16 v[196:197], v34 offset:36864
  s_add_u32 s63, s63, 4096
  buffer_load_dwordx4 v[244:247], v23, s[32:35], s63 offen offset:0 sc1
  buffer_load_dwordx4 v[248:251], v26, s[32:35], s63 offen offset:0 sc1
  buffer_load_dwordx4 v[108:111], v23, s[32:35], s63 offen offset:2048 sc1
  buffer_load_dwordx4 v[112:115], v26, s[32:35], s63 offen offset:2048 sc1
  s_waitcnt lgkmcnt(5)
  v_mfma_f32_32x32x16_bf16 v[88:103], v[208:211], v[220:223], v[88:103]
  ds_read_b64_tr_b16 v[198:199], v34 offset:37888
  s_waitcnt vmcnt(14)
  v_mfma_f32_32x32x16_bf16 v[72:87], v[204:207], v[224:227], v[72:87]
  ds_read_b64_tr_b16 v[200:201], v35 offset:36864
  v_mfma_f32_32x32x16_bf16 v[116:131], v[208:211], v[224:227], v[116:131]
  ds_read_b64_tr_b16 v[202:203], v35 offset:37888
  s_waitcnt vmcnt(13) lgkmcnt(6)
  v_mfma_f32_32x32x16_bf16 v[56:71], v[212:215], v[36:39], v[56:71]
  ds_read_b64_tr_b16 v[204:205], v34 offset:38912
  s_add_u32 s63, s20, 4
  s_sub_u32 s56, s63, 7
  s_cmp_ge_u32 s63, 7
  s_cselect_b32 s63, s56, s63
  s_lshl_b32 s63, s63, 13
  s_add_u32 s63, s63, s60
  buffer_load_dwordx4 v[220:223], v23, s[32:35], s63 offen offset:0 sc1
  buffer_load_dwordx4 v[224:227], v26, s[32:35], s63 offen offset:0 sc1
  s_waitcnt lgkmcnt(5)
  v_mfma_f32_32x32x16_bf16 v[88:103], v[216:219], v[36:39], v[88:103]
  ds_read_b64_tr_b16 v[206:207], v34 offset:39936
  s_waitcnt vmcnt(14)
  v_mfma_f32_32x32x16_bf16 v[72:87], v[212:215], v[40:43], v[72:87]
  ds_read_b64_tr_b16 v[208:209], v35 offset:38912
  v_mfma_f32_32x32x16_bf16 v[116:131], v[216:219], v[40:43], v[116:131]
  ds_read_b64_tr_b16 v[210:211], v35 offset:39936
  s_waitcnt vmcnt(13) lgkmcnt(6)
  v_mfma_f32_32x32x16_bf16 v[56:71], v[196:199], v[228:231], v[56:71]
  ds_read_b64_tr_b16 v[212:213], v34 offset:0
  buffer_load_dwordx4 v[36:39], v23, s[32:35], s63 offen offset:2048 sc1
  buffer_load_dwordx4 v[40:43], v26, s[32:35], s63 offen offset:2048 sc1
  s_waitcnt lgkmcnt(5)
  v_mfma_f32_32x32x16_bf16 v[88:103], v[200:203], v[228:231], v[88:103]
  ds_read_b64_tr_b16 v[214:215], v34 offset:1024
  s_waitcnt vmcnt(14)
  v_mfma_f32_32x32x16_bf16 v[72:87], v[196:199], v[232:235], v[72:87]
  ds_read_b64_tr_b16 v[216:217], v35 offset:0
  v_mfma_f32_32x32x16_bf16 v[116:131], v[200:203], v[232:235], v[116:131]
  ds_read_b64_tr_b16 v[218:219], v35 offset:1024
  s_waitcnt vmcnt(13) lgkmcnt(6)
  v_mfma_f32_32x32x16_bf16 v[56:71], v[204:207], v[44:47], v[56:71]
  ds_read_b64_tr_b16 v[196:197], v34 offset:2048
  s_add_u32 s63, s63, 4096
  buffer_load_dwordx4 v[228:231], v23, s[32:35], s63 offen offset:0 sc1
  buffer_load_dwordx4 v[232:235], v26, s[32:35], s63 offen offset:0 sc1
  s_waitcnt lgkmcnt(5)
  v_mfma_f32_32x32x16_bf16 v[88:103], v[208:211], v[44:47], v[88:103]
  ds_read_b64_tr_b16 v[198:199], v34 offset:3072
  s_waitcnt vmcnt(14)
  v_mfma_f32_32x32x16_bf16 v[72:87], v[204:207], v[48:51], v[72:87]
  ds_read_b64_tr_b16 v[200:201], v35 offset:2048
  v_mfma_f32_32x32x16_bf16 v[116:131], v[208:211], v[48:51], v[116:131]
  ds_read_b64_tr_b16 v[202:203], v35 offset:3072
  s_waitcnt vmcnt(13) lgkmcnt(6)
  v_mfma_f32_32x32x16_bf16 v[56:71], v[212:215], v[236:239], v[56:71]
  ds_read_b64_tr_b16 v[204:205], v34 offset:4096
  buffer_load_dwordx4 v[44:47], v23, s[32:35], s63 offen offset:2048 sc1
  buffer_load_dwordx4 v[48:51], v26, s[32:35], s63 offen offset:2048 sc1
  s_waitcnt lgkmcnt(5)
  v_mfma_f32_32x32x16_bf16 v[88:103], v[216:219], v[236:239], v[88:103]
  ds_read_b64_tr_b16 v[206:207], v34 offset:5120
  s_waitcnt vmcnt(14)
  v_mfma_f32_32x32x16_bf16 v[72:87], v[212:215], v[240:243], v[72:87]
  ds_read_b64_tr_b16 v[208:209], v35 offset:4096
  v_mfma_f32_32x32x16_bf16 v[116:131], v[216:219], v[240:243], v[116:131]
  ds_read_b64_tr_b16 v[210:211], v35 offset:5120
  s_waitcnt vmcnt(13) lgkmcnt(6)
  v_mfma_f32_32x32x16_bf16 v[56:71], v[196:199], v[52:55], v[56:71]
  ds_read_b64_tr_b16 v[212:213], v34 offset:6144
  s_add_u32 s63, s20, 5
  s_sub_u32 s56, s63, 7
  s_cmp_ge_u32 s63, 7
  s_cselect_b32 s63, s56, s63
  s_lshl_b32 s63, s63, 13
  s_add_u32 s63, s63, s60
  buffer_load_dwordx4 v[236:239], v23, s[32:35], s63 offen offset:0 sc1
  buffer_load_dwordx4 v[240:243], v26, s[32:35], s63 offen offset:0 sc1
  s_waitcnt lgkmcnt(5)
  v_mfma_f32_32x32x16_bf16 v[88:103], v[200:203], v[52:55], v[88:103]
  ds_read_b64_tr_b16 v[214:215], v34 offset:7168
  s_waitcnt vmcnt(14)
  v_mfma_f32_32x32x16_bf16 v[72:87], v[196:199], v[104:107], v[72:87]
  ds_read_b64_tr_b16 v[216:217], v35 offset:6144
  v_mfma_f32_32x32x16_bf16 v[116:131], v[200:203], v[104:107], v[116:131]
  ds_read_b64_tr_b16 v[218:219], v35 offset:7168
  v_mov_b32 v3, EP_G_s01
  s_mov_b64 exec, 1
  ds_write_b32 v28, v3
  s_mov_b64 exec, -1
  s_waitcnt vmcnt(13) lgkmcnt(7)
  v_mfma_f32_32x32x16_bf16 v[56:71], v[204:207], v[244:247], v[56:71]
  ds_read_b64_tr_b16 v[196:197], v32 offset:0
  buffer_load_dwordx4 v[52:55], v23, s[32:35], s63 offen offset:2048 sc1
  buffer_load_dwordx4 v[104:107], v26, s[32:35], s63 offen offset:2048 sc1
  s_waitcnt lgkmcnt(6)
  v_mfma_f32_32x32x16_bf16 v[88:103], v[208:211], v[244:247], v[88:103]
  ds_read_b64_tr_b16 v[198:199], v32 offset:1024
  s_waitcnt vmcnt(14)
  v_mfma_f32_32x32x16_bf16 v[72:87], v[204:207], v[248:251], v[72:87]
  ds_read_b64_tr_b16 v[200:201], v33 offset:0
  v_mfma_f32_32x32x16_bf16 v[116:131], v[208:211], v[248:251], v[116:131]
  ds_read_b64_tr_b16 v[202:203], v33 offset:1024
  s_waitcnt vmcnt(13) lgkmcnt(7)
  v_mfma_f32_32x32x16_bf16 v[56:71], v[212:215], v[108:111], v[56:71]
  ds_read_b64_tr_b16 v[204:205], v32 offset:2048
  s_add_u32 s63, s63, 4096
  buffer_load_dwordx4 v[244:247], v23, s[32:35], s63 offen offset:0 sc1
  buffer_load_dwordx4 v[248:251], v26, s[32:35], s63 offen offset:0 sc1
  s_waitcnt lgkmcnt(6)
  v_mfma_f32_32x32x16_bf16 v[88:103], v[216:219], v[108:111], v[88:103]
  ds_read_b64_tr_b16 v[206:207], v32 offset:3072
  s_waitcnt vmcnt(14)
  v_mfma_f32_32x32x16_bf16 v[72:87], v[212:215], v[112:115], v[72:87]
  ds_read_b64_tr_b16 v[208:209], v33 offset:2048
  v_mfma_f32_32x32x16_bf16 v[116:131], v[216:219], v[112:115], v[116:131]
  ds_read_b64_tr_b16 v[210:211], v33 offset:3072
  s_waitcnt vmcnt(13) lgkmcnt(6)
  v_mfma_f32_32x32x16_bf16 v[56:71], v[196:199], v[220:223], v[56:71]
  ds_read_b64_tr_b16 v[212:213], v32 offset:4096
  buffer_load_dwordx4 v[108:111], v23, s[32:35], s63 offen offset:2048 sc1
  buffer_load_dwordx4 v[112:115], v26, s[32:35], s63 offen offset:2048 sc1
  s_waitcnt lgkmcnt(5)
  v_mfma_f32_32x32x16_bf16 v[88:103], v[200:203], v[220:223], v[88:103]
  ds_read_b64_tr_b16 v[214:215], v32 offset:5120
  s_waitcnt vmcnt(14)
  v_mfma_f32_32x32x16_bf16 v[72:87], v[196:199], v[224:227], v[72:87]
  ds_read_b64_tr_b16 v[216:217], v33 offset:4096
  v_mfma_f32_32x32x16_bf16 v[116:131], v[200:203], v[224:227], v[116:131]
  ds_read_b64_tr_b16 v[218:219], v33 offset:5120
  s_waitcnt vmcnt(13) lgkmcnt(6)
  v_mfma_f32_32x32x16_bf16 v[56:71], v[204:207], v[36:39], v[56:71]
  ds_read_b64_tr_b16 v[196:197], v32 offset:6144
  s_add_u32 s63, s20, 1
  s_sub_u32 s56, s63, 7
  s_cmp_ge_u32 s63, 7
  s_cselect_b32 s63, s56, s63
  s_lshl_b32 s63, s63, 13
  s_add_u32 s63, s63, s60
  buffer_load_dwordx4 v[220:223], v23, s[32:35], s63 offen offset:0 sc1
  buffer_load_dwordx4 v[224:227], v26, s[32:35], s63 offen offset:0 sc1
  s_waitcnt lgkmcnt(5)
  v_mfma_f32_32x32x16_bf16 v[88:103], v[208:211], v[36:39], v[88:103]
  ds_read_b64_tr_b16 v[198:199], v32 offset:7168
  s_waitcnt vmcnt(14)
  v_mfma_f32_32x32x16_bf16 v[72:87], v[204:207], v[40:43], v[72:87]
  ds_read_b64_tr_b16 v[200:201], v33 offset:6144
  v_mfma_f32_32x32x16_bf16 v[116:131], v[208:211], v[40:43], v[116:131]
  ds_read_b64_tr_b16 v[202:203], v33 offset:7168
  s_waitcnt vmcnt(13) lgkmcnt(6)
  v_mfma_f32_32x32x16_bf16 v[56:71], v[212:215], v[228:231], v[56:71]
  ds_read_b64_tr_b16 v[204:205], v32 offset:32768
  buffer_load_dwordx4 v[36:39], v23, s[32:35], s63 offen offset:2048 sc1
  buffer_load_dwordx4 v[40:43], v26, s[32:35], s63 offen offset:2048 sc1
  s_waitcnt lgkmcnt(5)
  v_mfma_f32_32x32x16_bf16 v[88:103], v[216:219], v[228:231], v[88:103]
  ds_read_b64_tr_b16 v[206:207], v32 offset:33792
  s_waitcnt vmcnt(14)
  v_mfma_f32_32x32x16_bf16 v[72:87], v[212:215], v[232:235], v[72:87]
  ds_read_b64_tr_b16 v[208:209], v33 offset:32768
  v_mfma_f32_32x32x16_bf16 v[116:131], v[216:219], v[232:235], v[116:131]
  ds_read_b64_tr_b16 v[210:211], v33 offset:33792
  v_mov_b32 v3, EP_G_t3
  s_mov_b64 exec, 1
  ds_write_b32 v28, v3
  s_mov_b64 exec, -1
  s_waitcnt vmcnt(13) lgkmcnt(7)
  v_mfma_f32_32x32x16_bf16 v[56:71], v[196:199], v[44:47], v[56:71]
  ds_read_b64_tr_b16 v[212:213], v32 offset:34816
  s_add_u32 s63, s63, 4096
  buffer_load_dwordx4 v[228:231], v23, s[32:35], s63 offen offset:0 sc1
  buffer_load_dwordx4 v[232:235], v26, s[32:35], s63 offen offset:0 sc1
  s_waitcnt lgkmcnt(6)
  v_mfma_f32_32x32x16_bf16 v[88:103], v[200:203], v[44:47], v[88:103]
  ds_read_b64_tr_b16 v[214:215], v32 offset:35840
  s_waitcnt vmcnt(14)
  v_mfma_f32_32x32x16_bf16 v[72:87], v[196:199], v[48:51], v[72:87]
  ds_read_b64_tr_b16 v[216:217], v33 offset:34816
  v_mfma_f32_32x32x16_bf16 v[116:131], v[200:203], v[48:51], v[116:131]
  ds_read_b64_tr_b16 v[218:219], v33 offset:35840
  s_waitcnt vmcnt(13) lgkmcnt(7)
  v_mfma_f32_32x32x16_bf16 v[56:71], v[204:207], v[236:239], v[56:71]
  ds_read_b64_tr_b16 v[196:197], v32 offset:36864
  buffer_load_dwordx4 v[44:47], v23, s[32:35], s63 offen offset:2048 sc1
  buffer_load_dwordx4 v[48:51], v26, s[32:35], s63 offen offset:2048 sc1
  s_waitcnt lgkmcnt(6)
  v_mfma_f32_32x32x16_bf16 v[88:103], v[208:211], v[236:239], v[88:103]
  ds_read_b64_tr_b16 v[198:199], v32 offset:37888
  s_waitcnt vmcnt(14)
  v_mfma_f32_32x32x16_bf16 v[72:87], v[204:207], v[240:243], v[72:87]
  ds_read_b64_tr_b16 v[200:201], v33 offset:36864
  v_mfma_f32_32x32x16_bf16 v[116:131], v[208:211], v[240:243], v[116:131]
  ds_read_b64_tr_b16 v[202:203], v33 offset:37888
  s_waitcnt vmcnt(13) lgkmcnt(6)
  v_mfma_f32_32x32x16_bf16 v[56:71], v[212:215], v[52:55], v[56:71]
  ds_read_b64_tr_b16 v[204:205], v32 offset:38912
  s_add_u32 s63, s20, 2
  s_sub_u32 s56, s63, 7
  s_cmp_ge_u32 s63, 7
  s_cselect_b32 s63, s56, s63
  s_lshl_b32 s63, s63, 13
  s_add_u32 s63, s63, s60
  buffer_load_dwordx4 v[236:239], v23, s[32:35], s63 offen offset:0 sc1
  buffer_load_dwordx4 v[240:243], v26, s[32:35], s63 offen offset:0 sc1
  s_waitcnt lgkmcnt(5)
  v_mfma_f32_32x32x16_bf16 v[88:103], v[216:219], v[52:55], v[88:103]
  ds_read_b64_tr_b16 v[206:207], v32 offset:39936
  s_waitcnt vmcnt(14)
  v_mfma_f32_32x32x16_bf16 v[72:87], v[212:215], v[104:107], v[72:87]
  ds_read_b64_tr_b16 v[208:209], v33 offset:38912
  v_mfma_f32_32x32x16_bf16 v[116:131], v[216:219], v[104:107], v[116:131]
  ds_read_b64_tr_b16 v[210:211], v33 offset:39936
  s_waitcnt vmcnt(13) lgkmcnt(6)
  v_mfma_f32_32x32x16_bf16 v[56:71], v[196:199], v[244:247], v[56:71]
  buffer_load_dwordx4 v[52:55], v23, s[32:35], s63 offen offset:2048 sc1
  buffer_load_dwordx4 v[104:107], v26, s[32:35], s63 offen offset:2048 sc1
  s_waitcnt lgkmcnt(4)
  v_mfma_f32_32x32x16_bf16 v[88:103], v[200:203], v[244:247], v[88:103]
  s_waitcnt vmcnt(14)
  v_mfma_f32_32x32x16_bf16 v[72:87], v[196:199], v[248:251], v[72:87]
  v_mfma_f32_32x32x16_bf16 v[116:131], v[200:203], v[248:251], v[116:131]
  s_waitcnt vmcnt(13) lgkmcnt(2)
  v_mfma_f32_32x32x16_bf16 v[56:71], v[204:207], v[108:111], v[56:71]
  s_add_u32 s63, s63, 4096
  buffer_load_dwordx4 v[244:247], v23, s[32:35], s63 offen offset:0 sc1
  buffer_load_dwordx4 v[248:251], v26, s[32:35], s63 offen offset:0 sc1
  s_waitcnt lgkmcnt(0)
  v_mfma_f32_32x32x16_bf16 v[88:103], v[208:211], v[108:111], v[88:103]
  s_waitcnt vmcnt(14)
  v_mfma_f32_32x32x16_bf16 v[72:87], v[204:207], v[112:115], v[72:87]
  v_mfma_f32_32x32x16_bf16 v[116:131], v[208:211], v[112:115], v[116:131]
  ds_read_b32 v2, v27 offset:16
  s_waitcnt vmcnt(13)
  v_mfma_f32_32x32x16_bf16 v[56:71], v[132:135], v[220:223], v[56:71]
  buffer_load_dwordx4 v[108:111], v23, s[32:35], s63 offen offset:2048 sc1
  buffer_load_dwordx4 v[112:115], v26, s[32:35], s63 offen offset:2048 sc1
  v_mfma_f32_32x32x16_bf16 v[88:103], v[136:139], v[220:223], v[88:103]
  s_waitcnt vmcnt(14)
  v_mfma_f32_32x32x16_bf16 v[72:87], v[132:135], v[224:227], v[72:87]
  v_mfma_f32_32x32x16_bf16 v[116:131], v[136:139], v[224:227], v[116:131]
  s_waitcnt lgkmcnt(0)
  v_cmp_gt_u32 vcc, EP_H_xt, v2
  s_nop 0
  s_cbranch_vccnz L_aslow49
L_agot49:
  s_waitcnt vmcnt(13)
  v_mfma_f32_32x32x16_bf16 v[56:71], v[140:143], v[36:39], v[56:71]
  v_mfma_f32_32x32x16_bf16 v[88:103], v[144:147], v[36:39], v[88:103]
  s_waitcnt vmcnt(12)
  v_mfma_f32_32x32x16_bf16 v[72:87], v[140:143], v[40:43], v[72:87]
  v_mfma_f32_32x32x16_bf16 v[116:131], v[144:147], v[40:43], v[116:131]
  s_waitcnt vmcnt(11)
  v_mfma_f32_32x32x16_bf16 v[56:71], v[148:151], v[228:231], v[56:71]
  v_mfma_f32_32x32x16_bf16 v[88:103], v[152:155], v[228:231], v[88:103]
  s_waitcnt vmcnt(10)
  v_mfma_f32_32x32x16_bf16 v[72:87], v[148:151], v[232:235], v[72:87]
  v_mfma_f32_32x32x16_bf16 v[116:131], v[152:155], v[232:235], v[116:131]
  s_waitcnt vmcnt(9)
  v_mfma_f32_32x32x16_bf16 v[56:71], v[156:159], v[44:47], v[56:71]
  v_mfma_f32_32x32x16_bf16 v[88:103], v[160:163], v[44:47], v[88:103]
  s_waitcnt vmcnt(8)
  v_mfma_f32_32x32x16_bf16 v[72:87], v[156:159], v[48:51], v[72:87]
  v_mfma_f32_32x32x16_bf16 v[116:131], v[160:163], v[48:51], v[116:131]
  s_waitcnt vmcnt(7)
  v_mfma_f32_32x32x16_bf16 v[56:71], v[164:167], v[236:239], v[56:71]
  v_add_u32 v17, s62, v18
  v_xor_b32 v5, 8192, v17
  v_xor_b32 v6, 16384, v17
  v_mfma_f32_32x32x16_bf16 v[88:103], v[168:171], v[236:239], v[88:103]
  v_xor_b32 v7, 24576, v17
  s_lshr_b32 s44, s61, 1
  s_add_u32 s44, s44, 147456
  s_waitcnt vmcnt(6)
  v_mfma_f32_32x32x16_bf16 v[72:87], v[164:167], v[240:243], v[72:87]
  v_lshlrev_b32 v132, 6, v22
  v_lshl_add_u32 v132, v21, 3, v132
  v_add_u32 v132, s44, v132
  v_mfma_f32_32x32x16_bf16 v[116:131], v[168:171], v[240:243], v[116:131]
  v_add_u32 v133, s44, v18
  ds_read_b64 v[140:141], v132 offset:0
  ds_read_b64 v[142:143], v132 offset:16
  s_waitcnt vmcnt(5)
  v_mfma_f32_32x32x16_bf16 v[56:71], v[172:175], v[52:55], v[56:71]
  ds_read_b64 v[144:145], v132 offset:32
  ds_read_b64 v[146:147], v132 offset:48
  s_add_u32 s44, s61, 131072
  v_mfma_f32_32x32x16_bf16 v[88:103], v[176:179], v[52:55], v[88:103]
  v_add_u32 v134, s44, v18
  s_xor_b32 s44, s59, 1
  s_lshl_b32 s44, s44, 2
  s_waitcnt vmcnt(4)
  v_mfma_f32_32x32x16_bf16 v[72:87], v[172:175], v[104:107], v[72:87]
  s_add_u32 s44, s44, s58
  s_lshl_b32 s44, s44, 12
  s_add_u32 s44, s44, 65536
  v_mfma_f32_32x32x16_bf16 v[116:131], v[176:179], v[104:107], v[116:131]
  v_add_u32 v135, s44, v18
  v_lshlrev_b32 v29, 16, v29
  v_rcp_f32 v29, v29
  s_waitcnt lgkmcnt(3)
  v_lshlrev_b32 v148, 16, v140
  v_and_b32 v149, 0xffff0000, v140
  v_lshlrev_b32 v150, 16, v141
  v_and_b32 v151, 0xffff0000, v141
  s_waitcnt lgkmcnt(2)
  v_lshlrev_b32 v152, 16, v142
  v_and_b32 v153, 0xffff0000, v142
  v_lshlrev_b32 v154, 16, v143
  v_and_b32 v155, 0xffff0000, v143
  s_waitcnt lgkmcnt(1)
  v_lshlrev_b32 v228, 16, v144
  v_and_b32 v229, 0xffff0000, v144
  v_lshlrev_b32 v230, 16, v145
  v_and_b32 v231, 0xffff0000, v145
  s_waitcnt lgkmcnt(0)
  v_lshlrev_b32 v232, 16, v146
  v_and_b32 v233, 0xffff0000, v146
  v_lshlrev_b32 v234, 16, v147
  v_and_b32 v235, 0xffff0000, v147
  v_mul_f32 v42, 0xbfb8aa3b, v29
  v_mul_f32 v40, 0x36000000, v29
  s_waitcnt vmcnt(2)
  v_mfma_f32_32x32x16_bf16 v[116:131], v[184:187], v[248:251], v[116:131]
  s_waitcnt vmcnt(0)
  v_mfma_f32_32x32x16_bf16 v[116:131], v[192:195], v[112:115], v[116:131]
  v_mfma_f32_32x32x16_bf16 v[72:87], v[180:183], v[248:251], v[72:87]
  v_mfma_f32_32x32x16_bf16 v[72:87], v[188:191], v[112:115], v[72:87]
  v_mfma_f32_32x32x16_bf16 v[88:103], v[184:187], v[244:247], v[88:103]
  v_mfma_f32_32x32x16_bf16 v[88:103], v[192:195], v[108:111], v[88:103]
  s_nop 7
  ds_write_b128 v17, v[116:119] offset:32768
  ds_write_b128 v17, v[120:123] offset:33792
  ds_write_b128 v17, v[124:127] offset:34816
  ds_write_b128 v17, v[128:131] offset:35840
  v_mfma_f32_32x32x16_bf16 v[56:71], v[180:183], v[244:247], v[56:71]
  v_mfma_f32_32x32x16_bf16 v[56:71], v[188:191], v[108:111], v[56:71]
  ds_write_b128 v17, v[72:75] offset:4096
  ds_write_b128 v17, v[76:79] offset:5120
  ds_write_b128 v17, v[80:83] offset:6144
  ds_write_b128 v17, v[84:87] offset:7168
  ds_write_b128 v17, v[88:91] offset:0
  ds_write_b128 v17, v[92:95] offset:1024
  ds_write_b128 v17, v[96:99] offset:2048
  ds_write_b128 v17, v[100:103] offset:3072
  v_mov_b32 v3, EP_G_y
  s_mov_b64 exec, 1
  ds_write_b32 v28, v3
  s_mov_b64 exec, -1
  ds_read_b32 v2, v27 offset:0
  s_waitcnt lgkmcnt(0)
  v_cmp_gt_u32 vcc, EP_G_y, v2
  s_nop 0
  s_cbranch_vccnz L_aslow50
L_agot50:
  ds_read_b128 v[88:91], v5 offset:0
  ds_read_b128 v[72:75], v6 offset:4096
  ds_read_b128 v[116:119], v7 offset:32768
  ds_read_b128 v[92:95], v5 offset:1024
  ds_read_b128 v[76:79], v6 offset:5120
  ds_read_b128 v[120:123], v7 offset:33792
  ds_read_b128 v[96:99], v5 offset:2048
  ds_read_b128 v[80:83], v6 offset:6144
  ds_read_b128 v[124:127], v7 offset:34816
  ds_read_b128 v[100:103], v5 offset:3072
  ds_read_b128 v[84:87], v6 offset:7168
  ds_read_b128 v[128:131], v7 offset:35840
  s_waitcnt lgkmcnt(11)
  v_pk_add_f32 v[56:57], v[56:57], v[88:89]
  s_waitcnt lgkmcnt(9)
  v_pk_add_f32 v[72:73], v[72:73], v[116:117]
  v_pk_add_f32 v[58:59], v[58:59], v[90:91]
  v_pk_add_f32 v[74:75], v[74:75], v[118:119]
  v_pk_add_f32 v[56:57], v[56:57], v[72:73]
  v_pk_add_f32 v[58:59], v[58:59], v[74:75]
  v_pk_mul_f32 v[36:37], v[56:57], v[42:43] op_sel_hi:[1,0]
  v_pk_mul_f32 v[38:39], v[58:59], v[42:43] op_sel_hi:[1,0]
  v_exp_f32 v36, v36
  v_exp_f32 v37, v37
  v_exp_f32 v38, v38
  v_exp_f32 v39, v39
  v_pk_mul_f32 v[56:57], v[56:57], v[40:41] op_sel_hi:[1,0]
  v_pk_mul_f32 v[58:59], v[58:59], v[40:41] op_sel_hi:[1,0]
  v_add_f32 v36, 1.0, v36
  v_add_f32 v37, 1.0, v37
  v_add_f32 v38, 1.0, v38
  v_add_f32 v39, 1.0, v39
  v_rcp_f32 v36, v36
  v_rcp_f32 v37, v37
  v_rcp_f32 v38, v38
  v_rcp_f32 v39, v39
  v_pk_mul_f32 v[56:57], v[56:57], v[36:37]
  v_pk_mul_f32 v[58:59], v[58:59], v[38:39]
  s_waitcnt lgkmcnt(8)
  v_pk_add_f32 v[60:61], v[60:61], v[92:93]
  s_waitcnt lgkmcnt(6)
  v_pk_add_f32 v[76:77], v[76:77], v[120:121]
  v_pk_add_f32 v[62:63], v[62:63], v[94:95]
  v_pk_add_f32 v[78:79], v[78:79], v[122:123]
  v_pk_add_f32 v[60:61], v[60:61], v[76:77]
  v_pk_add_f32 v[62:63], v[62:63], v[78:79]
  v_pk_mul_f32 v[36:37], v[60:61], v[42:43] op_sel_hi:[1,0]
  v_pk_mul_f32 v[38:39], v[62:63], v[42:43] op_sel_hi:[1,0]
  v_exp_f32 v36, v36
  v_exp_f32 v37, v37
  v_exp_f32 v38, v38
  v_exp_f32 v39, v39
  v_pk_mul_f32 v[60:61], v[60:61], v[40:41] op_sel_hi:[1,0]
  v_pk_mul_f32 v[62:63], v[62:63], v[40:41] op_sel_hi:[1,0]
  v_add_f32 v36, 1.0, v36
  v_add_f32 v37, 1.0, v37
  v_add_f32 v38, 1.0, v38
  v_add_f32 v39, 1.0, v39
  v_rcp_f32 v36, v36
  v_rcp_f32 v37, v37
  v_rcp_f32 v38, v38
  v_rcp_f32 v39, v39
  v_pk_mul_f32 v[60:61], v[60:61], v[36:37]
  v_pk_mul_f32 v[62:63], v[62:63], v[38:39]
  s_waitcnt lgkmcnt(5)
  v_pk_add_f32 v[64:65], v[64:65], v[96:97]
  s_waitcnt lgkmcnt(3)
  v_pk_add_f32 v[80:81], v[80:81], v[124:125]
  v_pk_add_f32 v[66:67], v[66:67], v[98:99]
  v_pk_add_f32 v[82:83], v[82:83], v[126:127]
  v_pk_add_f32 v[64:65], v[64:65], v[80:81]
  v_pk_add_f32 v[66:67], v[66:67], v[82:83]
  v_pk_mul_f32 v[36:37], v[64:65], v[42:43] op_sel_hi:[1,0]
  v_pk_mul_f32 v[38:39], v[66:67], v[42:43] op_sel_hi:[1,0]
  v_exp_f32 v36, v36
  v_exp_f32 v37, v37
  v_exp_f32 v38, v38
  v_exp_f32 v39, v39
  v_pk_mul_f32 v[64:65], v[64:65], v[40:41] op_sel_hi:[1,0]
  v_pk_mul_f32 v[66:67], v[66:67], v[40:41] op_sel_hi:[1,0]
  v_add_f32 v36, 1.0, v36
  v_add_f32 v37, 1.0, v37
  v_add_f32 v38, 1.0, v38
  v_add_f32 v39, 1.0, v39
  v_rcp_f32 v36, v36
  v_rcp_f32 v37, v37
  v_rcp_f32 v38, v38
  v_rcp_f32 v39, v39
  ds_read_b32 v2, v27 offset:16
  v_pk_mul_f32 v[64:65], v[64:65], v[36:37]
  v_pk_mul_f32 v[66:67], v[66:67], v[38:39]
  s_waitcnt lgkmcnt(3)
  v_pk_add_f32 v[68:69], v[68:69], v[100:101]
  s_waitcnt lgkmcnt(1)
  v_pk_add_f32 v[84:85], v[84:85], v[128:129]
  v_pk_add_f32 v[70:71], v[70:71], v[102:103]
  v_pk_add_f32 v[86:87], v[86:87], v[130:131]
  v_pk_add_f32 v[68:69], v[68:69], v[84:85]
  v_pk_add_f32 v[70:71], v[70:71], v[86:87]
  v_pk_mul_f32 v[36:37], v[68:69], v[42:43] op_sel_hi:[1,0]
  v_pk_mul_f32 v[38:39], v[70:71], v[42:43] op_sel_hi:[1,0]
  v_exp_f32 v36, v36
  v_exp_f32 v37, v37
  v_exp_f32 v38, v38
  v_exp_f32 v39, v39
  v_pk_mul_f32 v[68:69], v[68:69], v[40:41] op_sel_hi:[1,0]
  v_pk_mul_f32 v[70:71], v[70:71], v[40:41] op_sel_hi:[1,0]
  v_add_f32 v36, 1.0, v36
  v_add_f32 v37, 1.0, v37
  v_add_f32 v38, 1.0, v38
  v_add_f32 v39, 1.0, v39
  v_rcp_f32 v36, v36
  v_rcp_f32 v37, v37
  v_rcp_f32 v38, v38
  v_rcp_f32 v39, v39
  s_waitcnt lgkmcnt(0)
  v_cmp_gt_u32 vcc, EP_H_done, v2
  s_nop 0
  s_cbranch_vccnz L_aslow51
L_agot51:
  ds_read_b128 v[156:159], v134 offset:0
  ds_read_b128 v[88:91], v135 offset:0
  ds_read_b128 v[160:163], v134 offset:1024
  ds_read_b128 v[92:95], v135 offset:1024
  ds_read_b128 v[44:47], v134 offset:2048
  ds_read_b128 v[96:99], v135 offset:2048
  ds_read_b128 v[48:51], v134 offset:3072
  ds_read_b128 v[100:103], v135 offset:3072
  v_pk_mul_f32 v[68:69], v[68:69], v[36:37]
  v_pk_mul_f32 v[70:71], v[70:71], v[38:39]
  s_waitcnt lgkmcnt(7)
  v_pk_fma_f32 v[148:149], v[56:57], v[156:157], v[148:149]
  v_pk_fma_f32 v[150:151], v[58:59], v[158:159], v[150:151]
  s_waitcnt lgkmcnt(6)
  v_pk_fma_f32 v[148:149], v[56:57], v[88:89], v[148:149]
  v_pk_fma_f32 v[150:151], v[58:59], v[90:91], v[150:151]
  v_cvt_pk_bf16_f32 v140, v148, v149
  v_cvt_pk_bf16_f32 v141, v150, v151
  ds_write_b64 v132, v[140:141] offset:0
  s_waitcnt lgkmcnt(6)
  v_pk_fma_f32 v[152:153], v[60:61], v[160:161], v[152:153]
  v_pk_fma_f32 v[154:155], v[62:63], v[162:163], v[154:155]
  s_waitcnt lgkmcnt(5)
  v_pk_fma_f32 v[152:153], v[60:61], v[92:93], v[152:153]
  v_pk_fma_f32 v[154:155], v[62:63], v[94:95], v[154:155]
  v_cvt_pk_bf16_f32 v142, v152, v153
  v_cvt_pk_bf16_f32 v143, v154, v155
  ds_write_b64 v132, v[142:143] offset:16
  s_waitcnt lgkmcnt(5)
  v_pk_fma_f32 v[228:229], v[64:65], v[44:45], v[228:229]
  v_pk_fma_f32 v[230:231], v[66:67], v[46:47], v[230:231]
  s_waitcnt lgkmcnt(4)
  v_pk_fma_f32 v[228:229], v[64:65], v[96:97], v[228:229]
  v_pk_fma_f32 v[230:231], v[66:67], v[98:99], v[230:231]
  v_cvt_pk_bf16_f32 v144, v228, v229
  v_cvt_pk_bf16_f32 v145, v230, v231
  ds_write_b64 v132, v[144:145] offset:32
  s_waitcnt lgkmcnt(4)
  v_pk_fma_f32 v[232:233], v[68:69], v[48:49], v[232:233]
  v_pk_fma_f32 v[234:235], v[70:71], v[50:51], v[234:235]
  s_waitcnt lgkmcnt(3)
  v_pk_fma_f32 v[232:233], v[68:69], v[100:101], v[232:233]
  v_pk_fma_f32 v[234:235], v[70:71], v[102:103], v[234:235]
  v_cvt_pk_bf16_f32 v146, v232, v233
  v_cvt_pk_bf16_f32 v147, v234, v235
  ds_write_b64 v132, v[146:147] offset:48
  ds_read_b128 v[156:159], v133 offset:0
  ds_read_b128 v[160:163], v133 offset:1024
  s_waitcnt lgkmcnt(1)
  buffer_store_dwordx4 v[156:159], v30, s[28:31], s54 offen offset:0
  s_waitcnt lgkmcnt(0)
  buffer_store_dwordx4 v[160:163], v31, s[28:31], s54 offen offset:1024
L_end:
  s_endpgm
L_H2:
  s_mov_b32 s8, s64
  s_and_b32 s9, s65, 0xffff
  s_mov_b32 s10, 2097152
  s_mov_b32 s11, 0x20000
  s_mov_b32 s24, s74
  s_and_b32 s25, s75, 0xffff
  s_mov_b32 s26, 1835008
  s_mov_b32 s27, 0x20000
  v_lshrrev_b32 v164, 2, v1
  v_lshl_add_u32 v164, v26, 4, v164
  v_mul_u32_u24 v164, 272, v164
  s_lshl_b32 s45, s38, 3
  s_add_u32 s45, s45, 139296
  v_add_u32 v60, s45, v164
  v_mov_b32 v62, 0x05040100
  v_mov_b32 v63, 0x07060302
  s_waitcnt vmcnt(22)
  v_readfirstlane_b32 s48, v29
  s_nop 0
  s_mul_i32 s39, s48, 0x9E3779B1
  s_add_u32 s39, s39, 0x7F4A7C15
  v_mov_b32 v20, s39
  s_waitcnt vmcnt(12)
  v_perm_b32 v52, v42, v40, v62
  v_perm_b32 v54, v42, v40, v63
  v_perm_b32 v56, v43, v41, v62
  v_perm_b32 v58, v43, v41, v63
  s_waitcnt vmcnt(10)
  v_perm_b32 v53, v46, v44, v62
  v_perm_b32 v55, v46, v44, v63
  v_perm_b32 v57, v47, v45, v62
  v_perm_b32 v59, v47, v45, v63
  ds_write_b64 v60, v[52:53] offset:0
  ds_write_b64 v60, v[54:55] offset:64
  ds_write_b64 v60, v[56:57] offset:128
  ds_write_b64 v60, v[58:59] offset:192
  s_waitcnt vmcnt(8)
  v_lshl_or_b32 v48, v49, 16, v48
  s_lshl_b32 s47, s38, 3
  s_add_u32 s47, s47, 156736
  v_lshl_add_u32 v5, v1, 2, s47
  s_mov_b64 exec, 3
  ds_write_b32 v5, v48
  s_mov_b64 exec, -1
  v_mov_b32 v3, EP_H_c0
  s_mov_b64 exec, 1
  ds_write_b32 v28, v3
  s_mov_b64 exec, -1
  s_mul_i32 s52, s53, 229376
  s_add_u32 s52, s52, s55
  s_add_u32 m0, s61, 81920
  s_nop 0
  buffer_load_dwordx4 v36, s[16:19], s52 offen offset:0 lds
  v_and_b32 v164, 1, v17
  v_lshlrev_b32 v165, 5, v164
  v_lshl_add_u32 v24, v26, 3, v165
  v_lshrrev_b32 v165, 3, v22
  v_lshlrev_b32 v165, 5, v165
  buffer_load_dwordx4 v37, s[16:19], s52 offen offset:1024 lds
  v_bfe_u32 v166, v1, 2, 1
  v_lshl_add_u32 v165, v166, 4, v165
  v_add_u32 v25, v165, v26
  v_lshlrev_b32 v165, 2, v164
  v_and_b32 v166, 7, v1
  buffer_load_dwordx4 v38, s[16:19], s52 offen offset:2048 lds
  v_xor_b32 v165, v165, v166
  v_lshlrev_b32 v30, 4, v165
  v_lshrrev_b32 v166, 3, v1
  v_lshl_add_u32 v12, v166, 10, v30
  v_add_u32 v13, 7168, v12
  buffer_load_dwordx4 v39, s[16:19], s52 offen offset:3072 lds
  v_add_u32 v14, 14336, v12
  v_add_u32 v15, 21504, v12
  v_lshl_add_u32 v165, v21, 2, v23
  v_lshl_add_u32 v165, v165, 7, v24
  v_lshrrev_b32 v166, 1, v23
  s_mul_i32 s52, s53, 128
  s_add_u32 s52, s52, s54
  s_add_u32 m0, s61, 65536
  s_nop 0
  buffer_load_dwordx4 v32, s[12:15], s52 offen offset:0 lds
  v_lshl_add_u32 v31, v166, 6, v165
  s_mul_i32 s7, s38, 458752
  s_lshl_b32 s20, s41, 7
  s_add_u32 s7, s7, s20
  s_mov_b32 s20, s36
  buffer_load_dwordx4 v33, s[12:15], s52 offen offset:1024 lds
  s_mul_i32 s23, s20, 37
  s_lshr_b32 s23, s23, 8
  s_mul_i32 s23, s23, 7
  s_sub_u32 s20, s20, s23
  s_add_u32 s40, s37, 4
  buffer_load_dwordx4 v34, s[12:15], s52 offen offset:2048 lds
  s_and_b32 s40, s40, 31
  s_lshl_b32 s44, s36, 5
  s_add_u32 s40, s40, s44
  s_lshr_b32 s57, s37, 3
  s_mul_i32 s57, s57, 458752
  buffer_load_dwordx4 v35, s[12:15], s52 offen offset:3072 lds
  s_and_b32 s44, s37, 7
  s_lshl_b32 s44, s44, 13
  s_add_u32 s57, s57, s44
  s_lshr_b32 s44, s61, 1
  s_add_u32 s57, s57, s44
  s_add_u32 s53, s53, 1
  s_and_b32 s53, s53, 7
  s_waitcnt vmcnt(8)
  v_mov_b32 v3, EP_H_c1
  s_mov_b64 exec, 1
  ds_write_b32 v28, v3
  s_mov_b64 exec, -1
  s_mul_i32 s52, s53, 229376
  s_add_u32 s52, s52, s55
  s_add_u32 m0, s61, 114688
  s_nop 0
  buffer_load_dwordx4 v36, s[16:19], s52 offen offset:0 lds
  v_lshlrev_b32 v183, 7, v1
  s_lshl_b32 s44, s21, 1
  s_and_b32 s23, s38, 1
  s_add_u32 s44, s44, s23
  s_lshl_b32 s23, s36, 2
  buffer_load_dwordx4 v37, s[16:19], s52 offen offset:1024 lds
  s_add_u32 s23, s23, s44
  s_mul_i32 s59, s23, 229376
  s_lshl_b32 s44, s22, 14
  s_add_u32 s59, s59, s44
  s_lshr_b32 s44, s38, 1
  buffer_load_dwordx4 v38, s[16:19], s52 offen offset:2048 lds
  s_lshl_b32 s44, s44, 13
  s_add_u32 s59, s59, s44
  s_add_u32 s59, s59, 8388608
  s_lshl_b32 s60, s36, 8
  s_add_u32 s60, s60, 118784
  buffer_load_dwordx4 v39, s[16:19], s52 offen offset:3072 lds
  v_lshrrev_b32 v164, 2, v1
  v_xor_b32 v165, v17, v26
  v_lshlrev_b32 v164, 7, v164
  v_lshl_add_u32 v172, v165, 4, v164
  v_add_u32 v173, 1024, v172
  s_mul_i32 s52, s53, 128
  s_add_u32 s52, s52, s54
  s_add_u32 m0, s61, 98304
  s_nop 0
  buffer_load_dwordx4 v32, s[12:15], s52 offen offset:0 lds
  v_add_u32 v174, 2048, v172
  v_add_u32 v175, 3072, v172
  s_lshr_b32 s56, s40, 1
  s_lshl_b32 s56, s56, 15
  s_and_b32 s44, s40, 1
  buffer_load_dwordx4 v33, s[12:15], s52 offen offset:1024 lds
  s_lshl_b32 s44, s44, 6
  s_add_u32 s56, s56, s44
  s_add_u32 s56, s56, s62
  s_add_u32 s56, s56, 1048576
  v_and_b32 v165, 1, v17
  buffer_load_dwordx4 v34, s[12:15], s52 offen offset:2048 lds
  v_xor_b32 v164, v23, v165
  v_lshlrev_b32 v165, 6, v16
  v_lshl_add_u32 v165, v164, 4, v165
  v_add_u32 v165, 131072, v165
  v_lshl_add_u32 v65, v21, 11, v165
  buffer_load_dwordx4 v35, s[12:15], s52 offen offset:3072 lds
  v_xor_b32 v165, 32, v165
  v_lshl_add_u32 v165, v21, 10, v165
  v_add_u32 v67, s61, v165
  s_lshl_b32 s44, s38, 4
  v_lshl_add_u32 v66, v17, 8, v16
  s_add_u32 s53, s53, 1
  s_and_b32 s53, s53, 7
  s_waitcnt vmcnt(8)
  v_mov_b32 v3, EP_H_c2
  s_mov_b64 exec, 1
  ds_write_b32 v28, v3
  s_mov_b64 exec, -1
  ds_read_b32 v2, v27 offset:0
  s_waitcnt lgkmcnt(0)
  v_cmp_gt_u32 vcc, EP_G_rel0, v2
  s_nop 0
  s_cbranch_vccnz L_aslow1
L_agot1:
  s_mul_i32 s52, s53, 229376
  s_add_u32 s52, s52, s55
  s_add_u32 m0, s61, 16384
  s_nop 0
  buffer_load_dwordx4 v36, s[16:19], s52 offen offset:0 lds
  v_add_u32 v66, s44, v66
  v_cvt_f32_u32 v171, s44
  s_and_b32 s44, s23, 3
  s_lshl_b32 s44, s44, 2
  s_lshl_b32 s45, s36, 8
  buffer_load_dwordx4 v37, s[16:19], s52 offen offset:1024 lds
  s_add_u32 s44, s44, s45
  s_lshl_b32 s44, s44, 3
  s_add_u32 s44, s44, 98304
  v_lshlrev_b32 v164, 3, v25
  v_lshl_add_u32 v164, v21, 10, v164
  buffer_load_dwordx4 v38, s[16:19], s52 offen offset:2048 lds
  v_add_u32 v180, s44, v164
  s_lshl_b32 s44, s38, 8
  s_add_u32 s44, s44, 157952
  v_lshl_add_u32 v181, v1, 2, s44
  s_lshl_b32 s44, s36, 9
  buffer_load_dwordx4 v39, s[16:19], s52 offen offset:3072 lds
  s_add_u32 s44, s44, 114688
  v_lshl_add_u32 v182, v22, 4, s44
  v_cvt_f32_u32 v61, v16
  v_lshlrev_b32 v164, 2, v17
  v_cvt_f32_u32 v64, v164
  s_mul_i32 s52, s53, 128
  s_add_u32 s52, s52, s54
  s_add_u32 m0, s61, 0
  s_nop 0
  buffer_load_dwordx4 v32, s[12:15], s52 offen offset:0 lds
  v_mul_f32 v164, 0x3d000000, v61
  v_mul_f32 v165, v164, v64
  v_and_b32 v166, 1, v1
  v_mul_u32_u24 v166, 0x8000, v166
  v_lshl_or_b32 v166, v166, 16, v166
  buffer_load_dwordx4 v33, s[12:15], s52 offen offset:1024 lds
  v_cos_f32 v167, v165
  v_sin_f32 v168, v165
  v_add_f32 v165, v165, v164
  v_cvt_pk_bf16_f32 v68, v167, v168
  v_cvt_pk_bf16_f32 v72, -v168, v167
  buffer_load_dwordx4 v34, s[12:15], s52 offen offset:2048 lds
  v_xor_b32 v76, v166, v68
  v_xor_b32 v80, v166, v72
  v_cos_f32 v167, v165
  v_sin_f32 v168, v165
  v_add_f32 v165, v165, v164
  buffer_load_dwordx4 v35, s[12:15], s52 offen offset:3072 lds
  v_cvt_pk_bf16_f32 v69, v167, v168
  v_cvt_pk_bf16_f32 v73, -v168, v167
  v_xor_b32 v77, v166, v69
  v_xor_b32 v81, v166, v73
  v_cos_f32 v167, v165
  s_add_u32 s53, s53, 1
  s_and_b32 s53, s53, 7
  s_add_u32 s63, s36, 0
  s_sub_u32 s52, s63, 7
  s_cmp_ge_u32 s63, 7
  s_cselect_b32 s63, s52, s63
  s_lshl_b32 s63, s63, 16
  s_add_u32 s63, s63, s57
  s_mov_b64 exec, 0xffff
  buffer_load_dword v255, v183, s[24:27], s63 offen
  s_mov_b64 exec, -1
  s_add_u32 s63, s36, 1
  s_sub_u32 s52, s63, 7
  s_cmp_ge_u32 s63, 7
  s_cselect_b32 s63, s52, s63
  s_lshl_b32 s63, s63, 16
  s_add_u32 s63, s63, s57
  s_mov_b64 exec, 0xffff
  buffer_load_dword v255, v183, s[24:27], s63 offen
  s_mov_b64 exec, -1
  s_waitcnt vmcnt(10)
  v_mov_b32 v3, EP_H_c3
  s_mov_b64 exec, 1
  ds_write_b32 v28, v3
  s_mov_b64 exec, -1
  buffer_load_dwordx2 v[176:177], v180, s[32:35], 0 offen sc1
  buffer_load_dword v178, v182, s[32:35], 0 offen sc1
  ds_read_b32 v2, v27 offset:0
  s_waitcnt lgkmcnt(0)
  v_cmp_gt_u32 vcc, EP_G_rel1, v2
  s_nop 0
  s_cbranch_vccnz L_aslow2
L_agot2:
  s_mul_i32 s52, s53, 229376
  s_add_u32 s52, s52, s55
  s_add_u32 m0, s61, 49152
  s_nop 0
  buffer_load_dwordx4 v36, s[16:19], s52 offen offset:0 lds
  v_sin_f32 v168, v165
  v_add_f32 v165, v165, v164
  v_cvt_pk_bf16_f32 v70, v167, v168
  v_cvt_pk_bf16_f32 v74, -v168, v167
  v_xor_b32 v78, v166, v70
  buffer_load_dwordx4 v37, s[16:19], s52 offen offset:1024 lds
  v_xor_b32 v82, v166, v74
  v_cos_f32 v167, v165
  v_sin_f32 v168, v165
  s_nop 0
  v_cvt_pk_bf16_f32 v71, v167, v168
  v_cvt_pk_bf16_f32 v75, -v168, v167
  buffer_load_dwordx4 v38, s[16:19], s52 offen offset:2048 lds
  v_xor_b32 v79, v166, v71
  v_xor_b32 v83, v166, v75
  v_mov_b32 v84, v68
  v_xor_b32 v85, 0x80008000, v69
  v_mov_b32 v86, v70
  buffer_load_dwordx4 v39, s[16:19], s52 offen offset:3072 lds
  v_xor_b32 v87, 0x80008000, v71
  v_mov_b32 v88, v72
  v_xor_b32 v89, 0x80008000, v73
  v_mov_b32 v90, v74
  v_xor_b32 v91, 0x80008000, v75
  s_mul_i32 s52, s53, 128
  s_add_u32 s52, s52, s54
  s_add_u32 m0, s61, 32768
  s_nop 0
  buffer_load_dwordx4 v32, s[12:15], s52 offen offset:0 lds
  v_mov_b32 v92, v76
  v_xor_b32 v93, 0x80008000, v77
  v_mov_b32 v94, v78
  v_xor_b32 v95, 0x80008000, v79
  v_mov_b32 v96, v80
  buffer_load_dwordx4 v33, s[12:15], s52 offen offset:1024 lds
  v_xor_b32 v97, 0x80008000, v81
  v_mov_b32 v98, v82
  v_xor_b32 v99, 0x80008000, v83
  v_add_f32 v169, v171, v61
  v_mul_f32 v169, 0x3c800000, v169
  buffer_load_dwordx4 v34, s[12:15], s52 offen offset:2048 lds
  v_mul_f32 v170, v169, v64
  v_fmamk_f32 v164, v169, 0x00000000, v170
  v_cos_f32 v165, v164
  v_sin_f32 v166, v164
  v_mul_f32 v167, 0x3d000000, v164
  buffer_load_dwordx4 v35, s[12:15], s52 offen offset:3072 lds
  v_cvt_pk_bf16_f32 v100, v165, v166
  v_cvt_pk_bf16_f32 v104, -v166, v165
  v_cos_f32 v132, v167
  v_sin_f32 v140, v167
  v_fmamk_f32 v164, v169, 0x3f800000, v170
  s_add_u32 s53, s53, 1
  s_and_b32 s53, s53, 7
  s_add_u32 s63, s36, 2
  s_sub_u32 s52, s63, 7
  s_cmp_ge_u32 s63, 7
  s_cselect_b32 s63, s52, s63
  s_lshl_b32 s63, s63, 16
  s_add_u32 s63, s63, s57
  s_mov_b64 exec, 0xffff
  buffer_load_dword v255, v183, s[24:27], s63 offen
  s_mov_b64 exec, -1
  s_add_u32 s63, s36, 3
  s_sub_u32 s52, s63, 7
  s_cmp_ge_u32 s63, 7
  s_cselect_b32 s63, s52, s63
  s_lshl_b32 s63, s63, 16
  s_add_u32 s63, s63, s57
  s_mov_b64 exec, 0xffff
  buffer_load_dword v255, v183, s[24:27], s63 offen
  s_mov_b64 exec, -1
  s_waitcnt vmcnt(14)
  v_mov_b32 v3, EP_H_c4
  s_mov_b64 exec, 1
  ds_write_b32 v28, v3
  s_mov_b64 exec, -1
  s_waitcnt vmcnt(11)
  v_cmp_ne_u32 vcc, s39, v177
  s_nop 0
  s_cbranch_vccnz L_slow3
L_got3:
  v_and_b32 v176, 0xffff0000, v176
  ds_write_b32 v181, v176
  s_getreg_b32 s47, hwreg(HW_REG_XCC_ID, 0, 4)
  s_mov_b32 s43, 0
  s_waitcnt vmcnt(10)
  v_mov_b32 v179, v178
L_xc4:
  v_subrev_u32 v179, s39, v178
  v_cmp_lt_u32 vcc, 15, v179
  s_nop 0
  s_cbranch_vccnz L_xcslow4
L_xcgo4:
  v_cmp_ne_u32 vcc, s47, v179
  s_nop 0
  s_cmp_lg_u64 vcc, 0
  s_cselect_b32 s6, 1, 0
  v_mov_b32 v179, s6
  ds_write_b32 v181, v179 offset:1024
  ds_read_b32 v2, v27 offset:0
  s_waitcnt lgkmcnt(0)
  v_cmp_gt_u32 vcc, EP_G_rel2, v2
  s_nop 0
  s_cbranch_vccnz L_aslow5
L_agot5:
  s_mul_i32 s52, s53, 229376
  s_add_u32 s52, s52, s55
  s_add_u32 m0, s61, 81920
  s_nop 0
  buffer_load_dwordx4 v36, s[16:19], s52 offen offset:0 lds
  v_cos_f32 v165, v164
  v_sin_f32 v166, v164
  v_mul_f32 v167, 0x3d000000, v164
  v_cvt_pk_bf16_f32 v101, v165, v166
  v_cvt_pk_bf16_f32 v105, -v166, v165
  buffer_load_dwordx4 v37, s[16:19], s52 offen offset:1024 lds
  v_cos_f32 v133, v167
  v_sin_f32 v141, v167
  v_fmamk_f32 v164, v169, 0x40000000, v170
  v_cos_f32 v165, v164
  v_sin_f32 v166, v164
  buffer_load_dwordx4 v38, s[16:19], s52 offen offset:2048 lds
  v_mul_f32 v167, 0x3d000000, v164
  v_cvt_pk_bf16_f32 v102, v165, v166
  v_cvt_pk_bf16_f32 v106, -v166, v165
  v_cos_f32 v134, v167
  v_sin_f32 v142, v167
  buffer_load_dwordx4 v39, s[16:19], s52 offen offset:3072 lds
  v_fmamk_f32 v164, v169, 0x40400000, v170
  v_cos_f32 v165, v164
  v_sin_f32 v166, v164
  v_mul_f32 v167, 0x3d000000, v164
  v_cvt_pk_bf16_f32 v103, v165, v166
  s_mul_i32 s52, s53, 128
  s_add_u32 s52, s52, s54
  s_add_u32 m0, s61, 65536
  s_nop 0
  buffer_load_dwordx4 v32, s[12:15], s52 offen offset:0 lds
  v_cvt_pk_bf16_f32 v107, -v166, v165
  v_cos_f32 v135, v167
  v_sin_f32 v143, v167
  v_fmamk_f32 v164, v169, 0x41800000, v170
  v_cos_f32 v165, v164
  buffer_load_dwordx4 v33, s[12:15], s52 offen offset:1024 lds
  v_sin_f32 v166, v164
  v_mul_f32 v167, 0x3d000000, v164
  v_cvt_pk_bf16_f32 v108, v165, v166
  v_cvt_pk_bf16_f32 v112, -v166, v165
  v_cos_f32 v136, v167
  buffer_load_dwordx4 v34, s[12:15], s52 offen offset:2048 lds
  v_sin_f32 v144, v167
  v_fmamk_f32 v164, v169, 0x41880000, v170
  v_cos_f32 v165, v164
  v_sin_f32 v166, v164
  v_mul_f32 v167, 0x3d000000, v164
  buffer_load_dwordx4 v35, s[12:15], s52 offen offset:3072 lds
  v_cvt_pk_bf16_f32 v109, v165, v166
  v_cvt_pk_bf16_f32 v113, -v166, v165
  v_cos_f32 v137, v167
  v_sin_f32 v145, v167
  v_fmamk_f32 v164, v169, 0x41900000, v170
  s_add_u32 s53, s53, 1
  s_and_b32 s53, s53, 7
  s_add_u32 s63, s36, 4
  s_sub_u32 s52, s63, 7
  s_cmp_ge_u32 s63, 7
  s_cselect_b32 s63, s52, s63
  s_lshl_b32 s63, s63, 16
  s_add_u32 s63, s63, s57
  s_mov_b64 exec, 0xffff
  buffer_load_dword v255, v183, s[24:27], s63 offen
  s_mov_b64 exec, -1
  s_add_u32 s63, s36, 5
  s_sub_u32 s52, s63, 7
  s_cmp_ge_u32 s63, 7
  s_cselect_b32 s63, s52, s63
  s_lshl_b32 s63, s63, 16
  s_add_u32 s63, s63, s57
  s_mov_b64 exec, 0xffff
  buffer_load_dword v255, v183, s[24:27], s63 offen
  s_mov_b64 exec, -1
  s_waitcnt vmcnt(12)
  v_mov_b32 v3, EP_H_c5
  s_mov_b64 exec, 1
  ds_write_b32 v28, v3
  s_mov_b64 exec, -1
  ds_read_b32 v2, v27 offset:0
  s_waitcnt lgkmcnt(0)
  v_cmp_gt_u32 vcc, EP_G_rel3, v2
  s_nop 0
  s_cbranch_vccnz L_aslow6
L_agot6:
  s_mul_i32 s52, s53, 229376
  s_add_u32 s52, s52, s55
  s_add_u32 m0, s61, 114688
  s_nop 0
  buffer_load_dwordx4 v36, s[16:19], s52 offen offset:0 lds
  v_cos_f32 v165, v164
  v_sin_f32 v166, v164
  v_mul_f32 v167, 0x3d000000, v164
  v_cvt_pk_bf16_f32 v110, v165, v166
  v_cvt_pk_bf16_f32 v114, -v166, v165
  buffer_load_dwordx4 v37, s[16:19], s52 offen offset:1024 lds
  v_cos_f32 v138, v167
  v_sin_f32 v146, v167
  v_fmamk_f32 v164, v169, 0x41980000, v170
  v_cos_f32 v165, v164
  v_sin_f32 v166, v164
  buffer_load_dwordx4 v38, s[16:19], s52 offen offset:2048 lds
  v_mul_f32 v167, 0x3d000000, v164
  v_cvt_pk_bf16_f32 v111, v165, v166
  v_cvt_pk_bf16_f32 v115, -v166, v165
  v_cos_f32 v139, v167
  v_sin_f32 v147, v167
  buffer_load_dwordx4 v39, s[16:19], s52 offen offset:3072 lds
  v_fmamk_f32 v164, v169, 0x42000000, v170
  v_cos_f32 v165, v164
  v_sin_f32 v166, v164
  v_mul_f32 v167, 0x3d000000, v164
  v_cvt_pk_bf16_f32 v116, v165, v166
  s_mul_i32 s52, s53, 128
  s_add_u32 s52, s52, s54
  s_add_u32 m0, s61, 98304
  s_nop 0
  buffer_load_dwordx4 v32, s[12:15], s52 offen offset:0 lds
  v_cvt_pk_bf16_f32 v120, -v166, v165
  v_fmamk_f32 v164, v169, 0x42040000, v170
  v_cos_f32 v165, v164
  v_sin_f32 v166, v164
  v_mul_f32 v167, 0x3d000000, v164
  buffer_load_dwordx4 v33, s[12:15], s52 offen offset:1024 lds
  v_cvt_pk_bf16_f32 v117, v165, v166
  v_cvt_pk_bf16_f32 v121, -v166, v165
  v_fmamk_f32 v164, v169, 0x42080000, v170
  v_cos_f32 v165, v164
  v_sin_f32 v166, v164
  buffer_load_dwordx4 v34, s[12:15], s52 offen offset:2048 lds
  v_mul_f32 v167, 0x3d000000, v164
  v_cvt_pk_bf16_f32 v118, v165, v166
  v_cvt_pk_bf16_f32 v122, -v166, v165
  v_fmamk_f32 v164, v169, 0x420c0000, v170
  v_cos_f32 v165, v164
  buffer_load_dwordx4 v35, s[12:15], s52 offen offset:3072 lds
  v_sin_f32 v166, v164
  v_mul_f32 v167, 0x3d000000, v164
  v_cvt_pk_bf16_f32 v119, v165, v166
  v_cvt_pk_bf16_f32 v123, -v166, v165
  v_fmamk_f32 v164, v169, 0x42400000, v170
  s_add_u32 s53, s53, 1
  s_and_b32 s53, s53, 7
  s_add_u32 s63, s36, 6
  s_sub_u32 s52, s63, 7
  s_cmp_ge_u32 s63, 7
  s_cselect_b32 s63, s52, s63
  s_lshl_b32 s63, s63, 16
  s_add_u32 s63, s63, s57
  s_mov_b64 exec, 0xffff
  buffer_load_dword v255, v183, s[24:27], s63 offen
  s_mov_b64 exec, -1
  s_waitcnt vmcnt(11)
  v_mov_b32 v3, EP_H_c6
  s_mov_b64 exec, 1
  ds_write_b32 v28, v3
  s_mov_b64 exec, -1
  v_cos_f32 v165, v164
  v_sin_f32 v166, v164
  v_mul_f32 v167, 0x3d000000, v164
  v_cvt_pk_bf16_f32 v124, v165, v166
  v_cvt_pk_bf16_f32 v128, -v166, v165
  v_fmamk_f32 v164, v169, 0x42440000, v170
  v_cos_f32 v165, v164
  v_sin_f32 v166, v164
  v_mul_f32 v167, 0x3d000000, v164
  v_cvt_pk_bf16_f32 v125, v165, v166
  v_cvt_pk_bf16_f32 v129, -v166, v165
  v_fmamk_f32 v164, v169, 0x42480000, v170
  v_cos_f32 v165, v164
  v_sin_f32 v166, v164
  v_mul_f32 v167, 0x3d000000, v164
  v_cvt_pk_bf16_f32 v126, v165, v166
  v_cvt_pk_bf16_f32 v130, -v166, v165
  v_fmamk_f32 v164, v169, 0x424c0000, v170
  v_cos_f32 v165, v164
  v_sin_f32 v166, v164
  v_mul_f32 v167, 0x3d000000, v164
  v_cvt_pk_bf16_f32 v127, v165, v166
  v_cvt_pk_bf16_f32 v131, -v166, v165
  v_add_f32 v168, v171, v64
  v_add_f32 v169, 0x00000000, v61
  v_mul_f32 v169, 0x3a000000, v169
  v_mul_f32 v170, v169, v168
  v_fmamk_f32 v164, v169, 0x00000000, v170
  v_cos_f32 v148, v164
  v_sin_f32 v156, v164
  v_fmamk_f32 v164, v169, 0x3f800000, v170
  v_cos_f32 v149, v164
  v_sin_f32 v157, v164
  v_fmamk_f32 v164, v169, 0x40000000, v170
  v_cos_f32 v150, v164
  v_sin_f32 v158, v164
  v_fmamk_f32 v164, v169, 0x40400000, v170
  v_cos_f32 v151, v164
  v_sin_f32 v159, v164
  v_add_f32 v169, 0x41800000, v61
  v_mul_f32 v169, 0x3a000000, v169
  v_mul_f32 v170, v169, v168
  v_fmamk_f32 v164, v169, 0x00000000, v170
  v_cos_f32 v152, v164
  v_sin_f32 v160, v164
  v_fmamk_f32 v164, v169, 0x3f800000, v170
  v_cos_f32 v153, v164
  v_sin_f32 v161, v164
  v_fmamk_f32 v164, v169, 0x40000000, v170
  v_cos_f32 v154, v164
  v_sin_f32 v162, v164
  v_fmamk_f32 v164, v169, 0x40400000, v170
  v_cos_f32 v155, v164
  v_sin_f32 v163, v164
  ds_read_b32 v2, v27 offset:0
  s_waitcnt lgkmcnt(0)
  v_cmp_gt_u32 vcc, EP_G_rel4, v2
  s_nop 0
  s_cbranch_vccnz L_aslow7
L_agot7:
  s_mov_b32 s52, s20
  s_lshl_b32 s52, s52, 16
  s_add_u32 s52, s52, s7
  s_add_u32 m0, s62, 0
  s_nop 0
  buffer_load_dwordx4 v12, s[24:27], s52 offen offset:0 lds
  buffer_load_dwordx4 v13, s[24:27], s52 offen offset:1024 lds
  buffer_load_dwordx4 v14, s[24:27], s52 offen offset:2048 lds
  buffer_load_dwordx4 v15, s[24:27], s52 offen offset:3072 lds
  s_add_u32 s52, s52, 32768
  s_add_u32 m0, s62, 4096
  s_nop 0
  buffer_load_dwordx4 v12, s[24:27], s52 offen offset:0 lds
  buffer_load_dwordx4 v13, s[24:27], s52 offen offset:1024 lds
  buffer_load_dwordx4 v14, s[24:27], s52 offen offset:2048 lds
  buffer_load_dwordx4 v15, s[24:27], s52 offen offset:3072 lds
  s_waitcnt vmcnt(9)
  v_mov_b32 v3, EP_H_c7
  s_mov_b64 exec, 1
  ds_write_b32 v28, v3
  s_mov_b64 exec, -1
  buffer_load_dword v184, v19, s[32:35], s60 offen sc1
  ds_read_b32 v2, v27 offset:0
  s_waitcnt lgkmcnt(0)
  v_cmp_gt_u32 vcc, EP_G_rel5, v2
  s_nop 0
  s_cbranch_vccnz L_aslow8
L_agot8:
  s_add_u32 s52, s20, 1
  s_sub_u32 m0, s52, 7
  s_cmp_ge_u32 s52, 7
  s_cselect_b32 s52, m0, s52
  s_lshl_b32 s52, s52, 16
  s_add_u32 s52, s52, s7
  s_add_u32 m0, s62, 32768
  s_nop 0
  buffer_load_dwordx4 v12, s[24:27], s52 offen offset:0 lds
  buffer_load_dwordx4 v13, s[24:27], s52 offen offset:1024 lds
  buffer_load_dwordx4 v14, s[24:27], s52 offen offset:2048 lds
  buffer_load_dwordx4 v15, s[24:27], s52 offen offset:3072 lds
  s_add_u32 s52, s52, 32768
  s_add_u32 m0, s62, 36864
  s_nop 0
  buffer_load_dwordx4 v12, s[24:27], s52 offen offset:0 lds
  buffer_load_dwordx4 v13, s[24:27], s52 offen offset:1024 lds
  buffer_load_dwordx4 v14, s[24:27], s52 offen offset:2048 lds
  buffer_load_dwordx4 v15, s[24:27], s52 offen offset:3072 lds
  s_waitcnt vmcnt(8)
  v_cmp_ne_u32 vcc, s39, v184
  s_nop 0
  s_cbranch_vccnz L_slow9
L_got9:
  s_cmp_lg_u32 s40, 0
  s_cbranch_scc1 L_nown2
  s_lshr_b32 s52, s61, 1
  s_add_u32 m0, s52, 147456
  s_add_u32 s52, s52, 327680
  buffer_load_dwordx4 v18, s[32:35], s52 offen offset:0 sc1 lds
  buffer_load_dwordx4 v18, s[32:35], s52 offen offset:1024 sc1 lds
L_nown2:
  s_add_u32 m0, s61, 131072
  s_nop 0
  buffer_load_dwordx4 v172, s[32:35], s56 offen offset:0 sc1 lds
  buffer_load_dwordx4 v173, s[32:35], s56 offen offset:1024 sc1 lds
  buffer_load_dwordx4 v174, s[32:35], s56 offen offset:2048 sc1 lds
  buffer_load_dwordx4 v175, s[32:35], s56 offen offset:3072 sc1 lds
  ds_read_b32 v2, v27 offset:0
  s_waitcnt lgkmcnt(0)
  v_cmp_gt_u32 vcc, EP_G_rel6, v2
  s_nop 0
  s_cbranch_vccnz L_aslow10
L_agot10:
  s_add_u32 s52, s20, 2
  s_sub_u32 m0, s52, 7
  s_cmp_ge_u32 s52, 7
  s_cselect_b32 s52, m0, s52
  s_lshl_b32 s52, s52, 16
  s_add_u32 s52, s52, s7
  s_add_u32 m0, s62, 65536
  s_nop 0
  buffer_load_dwordx4 v12, s[24:27], s52 offen offset:0 lds
  buffer_load_dwordx4 v13, s[24:27], s52 offen offset:1024 lds
  buffer_load_dwordx4 v14, s[24:27], s52 offen offset:2048 lds
  buffer_load_dwordx4 v15, s[24:27], s52 offen offset:3072 lds
  s_add_u32 s52, s52, 32768
  s_add_u32 m0, s62, 69632
  s_nop 0
  buffer_load_dwordx4 v12, s[24:27], s52 offen offset:0 lds
  buffer_load_dwordx4 v13, s[24:27], s52 offen offset:1024 lds
  buffer_load_dwordx4 v14, s[24:27], s52 offen offset:2048 lds
  buffer_load_dwordx4 v15, s[24:27], s52 offen offset:3072 lds
  s_waitcnt vmcnt(8)
  v_mov_b32 v3, EP_H_xc
  s_mov_b64 exec, 1
  ds_write_b32 v28, v3
  s_mov_b64 exec, -1
  v_add_u32 v60, 131072, v18
  ds_read_b32 v2, v27 offset:16
  s_waitcnt lgkmcnt(0)
  v_cmp_gt_u32 vcc, EP_H_xc, v2
  s_nop 0
  s_cbranch_vccnz L_aslow11
L_agot11:
  s_setprio 1
  ds_read_b128 v[32:35], v65 offset:0
  ds_read_b128 v[48:51], v65 offset:1024
  ds_read_b128 v[36:39], v65 offset:4096
  ds_read_b128 v[52:55], v65 offset:5120
  ds_read_b128 v[40:43], v65 offset:8192
  ds_read_b128 v[56:59], v65 offset:9216
  ds_read_b128 v[44:47], v65 offset:12288
  ds_read_b128 v[172:175], v65 offset:13312
  s_or_b32 s44, s2, s38
  s_cmp_lg_u32 s44, 0
  s_cbranch_scc1 L_noepoch
  s_mov_b64 exec, 1
  buffer_store_dword v20, v19, s[32:35], 0 offen sc1
  s_mov_b64 exec, -1
L_noepoch:
  ds_read_b128 v[204:207], v67 offset:0
  ds_read_b128 v[208:211], v67 offset:2048
  s_waitcnt lgkmcnt(9)
  v_mfma_f32_16x16x32_bf16 v[176:179], v[32:35], v[100:103], 0
  v_mfma_f32_16x16x32_bf16 v[180:183], v[32:35], v[104:107], 0
  s_waitcnt lgkmcnt(8)
  v_mfma_f32_16x16x32_bf16 v[188:191], v[48:51], v[100:103], 0
  v_mfma_f32_16x16x32_bf16 v[192:195], v[48:51], v[104:107], 0
  s_waitcnt lgkmcnt(7)
  v_mfma_f32_16x16x32_bf16 v[176:179], v[36:39], v[108:111], v[176:179]
  v_mfma_f32_16x16x32_bf16 v[180:183], v[36:39], v[112:115], v[180:183]
  s_waitcnt lgkmcnt(6)
  v_mfma_f32_16x16x32_bf16 v[188:191], v[52:55], v[108:111], v[188:191]
  v_mfma_f32_16x16x32_bf16 v[192:195], v[52:55], v[112:115], v[192:195]
  s_waitcnt lgkmcnt(5)
  v_mfma_f32_16x16x32_bf16 v[176:179], v[40:43], v[116:119], v[176:179]
  v_mfma_f32_16x16x32_bf16 v[180:183], v[40:43], v[120:123], v[180:183]
  s_waitcnt lgkmcnt(4)
  v_mfma_f32_16x16x32_bf16 v[188:191], v[56:59], v[116:119], v[188:191]
  v_mfma_f32_16x16x32_bf16 v[192:195], v[56:59], v[120:123], v[192:195]
  s_waitcnt lgkmcnt(3)
  v_mfma_f32_16x16x32_bf16 v[176:179], v[44:47], v[124:127], v[176:179]
  v_mfma_f32_16x16x32_bf16 v[180:183], v[44:47], v[128:131], v[180:183]
  s_waitcnt lgkmcnt(2)
  v_mfma_f32_16x16x32_bf16 v[188:191], v[172:175], v[124:127], v[188:191]
  v_mfma_f32_16x16x32_bf16 v[192:195], v[172:175], v[128:131], v[192:195]
  s_waitcnt vmcnt(0)
  v_mov_b32 v3, EP_H_w2
  s_mov_b64 exec, 1
  ds_write_b32 v28, v3
  s_mov_b64 exec, -1
  v_mul_f32 v4, v176, v132
  v_mul_f32 v5, v180, v132
  v_fmac_f32 v4, v180, v140
  v_fma_f32 v5, -v176, v140, v5
  v_cvt_pk_bf16_f32 v196, v4, v5
  v_mul_f32 v6, v177, v133
  v_mul_f32 v7, v181, v133
  v_fmac_f32 v6, v181, v141
  v_fma_f32 v7, -v177, v141, v7
  v_cvt_pk_bf16_f32 v197, v6, v7
  v_mul_f32 v4, v178, v134
  v_mul_f32 v5, v182, v134
  v_fmac_f32 v4, v182, v142
  v_fma_f32 v5, -v178, v142, v5
  v_cvt_pk_bf16_f32 v198, v4, v5
  v_mul_f32 v6, v179, v135
  v_mul_f32 v7, v183, v135
  v_fmac_f32 v6, v183, v143
  v_fma_f32 v7, -v179, v143, v7
  v_cvt_pk_bf16_f32 v199, v6, v7
  v_mul_f32 v4, v188, v136
  v_mul_f32 v5, v192, v136
  v_fmac_f32 v4, v192, v144
  v_fma_f32 v5, -v188, v144, v5
  v_cvt_pk_bf16_f32 v200, v4, v5
  v_mul_f32 v6, v189, v137
  v_mul_f32 v7, v193, v137
  v_fmac_f32 v6, v193, v145
  v_fma_f32 v7, -v189, v145, v7
  v_cvt_pk_bf16_f32 v201, v6, v7
  v_mul_f32 v4, v190, v138
  v_mul_f32 v5, v194, v138
  v_fmac_f32 v4, v194, v146
  v_fma_f32 v5, -v190, v146, v5
  v_cvt_pk_bf16_f32 v202, v4, v5
  v_mul_f32 v6, v191, v139
  v_mul_f32 v7, v195, v139
  v_fmac_f32 v6, v195, v147
  v_fma_f32 v7, -v191, v147, v7
  v_cvt_pk_bf16_f32 v203, v6, v7
  v_mfma_f32_16x16x32_bf16 v[176:179], v[68:71], v[196:199], 0
  s_nop 0
  v_mfma_f32_16x16x32_bf16 v[176:179], v[76:79], v[200:203], v[176:179]
  v_mfma_f32_16x16x32_bf16 v[180:183], v[72:75], v[196:199], 0
  v_mfma_f32_16x16x32_bf16 v[180:183], v[80:83], v[200:203], v[180:183]
  v_mfma_f32_16x16x32_bf16 v[188:191], v[84:87], v[196:199], 0
  v_mfma_f32_16x16x32_bf16 v[188:191], v[92:95], v[200:203], v[188:191]
  v_mfma_f32_16x16x32_bf16 v[192:195], v[88:91], v[196:199], 0
  v_mfma_f32_16x16x32_bf16 v[192:195], v[96:99], v[200:203], v[192:195]
  s_cmp_eq_u32 s40, 0
  s_cbranch_scc1 L_special
  s_waitcnt lgkmcnt(2)
  v_lshlrev_b32 v8, 16, v204
  v_and_b32 v9, 0xffff0000, v204
  v_mul_f32 v4, v176, v8
  v_mul_f32 v5, v176, v9
  v_fma_f32 v4, -v180, v9, v4
  v_fmac_f32 v5, v180, v8
  v_cvt_pk_bf16_f32 v196, v4, -v5
  v_lshlrev_b32 v10, 16, v205
  v_and_b32 v11, 0xffff0000, v205
  v_mul_f32 v6, v177, v10
  v_mul_f32 v7, v177, v11
  v_fma_f32 v6, -v181, v11, v6
  v_fmac_f32 v7, v181, v10
  v_cvt_pk_bf16_f32 v197, v6, -v7
  v_lshlrev_b32 v8, 16, v206
  v_and_b32 v9, 0xffff0000, v206
  v_mul_f32 v4, v178, v8
  v_mul_f32 v5, v178, v9
  v_fma_f32 v4, -v182, v9, v4
  v_fmac_f32 v5, v182, v8
  v_cvt_pk_bf16_f32 v198, v4, -v5
  v_lshlrev_b32 v10, 16, v207
  v_and_b32 v11, 0xffff0000, v207
  v_mul_f32 v6, v179, v10
  v_mul_f32 v7, v179, v11
  v_fma_f32 v6, -v183, v11, v6
  v_fmac_f32 v7, v183, v10
  v_cvt_pk_bf16_f32 v199, v6, -v7
  s_waitcnt lgkmcnt(1)
  v_lshlrev_b32 v8, 16, v208
  v_and_b32 v9, 0xffff0000, v208
  v_mul_f32 v4, v188, v8
  v_mul_f32 v5, v188, v9
  v_fma_f32 v4, -v192, v9, v4
  v_fmac_f32 v5, v192, v8
  v_cvt_pk_bf16_f32 v200, v4, -v5
  v_lshlrev_b32 v10, 16, v209
  v_and_b32 v11, 0xffff0000, v209
  v_mul_f32 v6, v189, v10
  v_mul_f32 v7, v189, v11
  v_fma_f32 v6, -v193, v11, v6
  v_fmac_f32 v7, v193, v10
  v_cvt_pk_bf16_f32 v201, v6, -v7
  v_lshlrev_b32 v8, 16, v210
  v_and_b32 v9, 0xffff0000, v210
  v_mul_f32 v4, v190, v8
  v_mul_f32 v5, v190, v9
  v_fma_f32 v4, -v194, v9, v4
  v_fmac_f32 v5, v194, v8
  v_cvt_pk_bf16_f32 v202, v4, -v5
  v_lshlrev_b32 v10, 16, v211
  v_and_b32 v11, 0xffff0000, v211
  v_mul_f32 v6, v191, v10
  v_mul_f32 v7, v191, v11
  v_fma_f32 v6, -v195, v11, v6
  v_fmac_f32 v7, v195, v10
  v_cvt_pk_bf16_f32 v203, v6, -v7
L_special_done:
  v_mfma_f32_16x16x32_bf16 v[176:179], v[196:199], v[68:71], 0
  s_nop 0
  v_mfma_f32_16x16x32_bf16 v[176:179], v[200:203], v[76:79], v[176:179]
  v_mfma_f32_16x16x32_bf16 v[180:183], v[196:199], v[72:75], 0
  v_mfma_f32_16x16x32_bf16 v[180:183], v[200:203], v[80:83], v[180:183]
  v_mfma_f32_16x16x32_bf16 v[188:191], v[196:199], v[84:87], 0
  v_mfma_f32_16x16x32_bf16 v[188:191], v[200:203], v[92:95], v[188:191]
  v_mfma_f32_16x16x32_bf16 v[192:195], v[196:199], v[88:91], 0
  v_mfma_f32_16x16x32_bf16 v[192:195], v[200:203], v[96:99], v[192:195]
  s_lshr_b32 s44, s61, 2
  v_add_u32 v10, s44, v60
  v_mul_f32 v4, v176, v148
  s_nop 0
  v_mul_f32 v5, v180, v148
  v_fmac_f32 v4, v180, v156
  v_fma_f32 v5, -v176, v156, v5
  v_cvt_pk_bf16_f32 v32, v4, v5
  v_mul_f32 v6, v177, v149
  v_mul_f32 v7, v181, v149
  v_fmac_f32 v6, v181, v157
  v_fma_f32 v7, -v177, v157, v7
  v_cvt_pk_bf16_f32 v33, v6, v7
  v_mul_f32 v4, v178, v150
  v_mul_f32 v5, v182, v150
  v_fmac_f32 v4, v182, v158
  v_fma_f32 v5, -v178, v158, v5
  v_cvt_pk_bf16_f32 v34, v4, v5
  v_mul_f32 v6, v179, v151
  v_mul_f32 v7, v183, v151
  v_fmac_f32 v6, v183, v159
  v_fma_f32 v7, -v179, v159, v7
  v_cvt_pk_bf16_f32 v35, v6, v7
  ds_write_b128 v10, v[32:35] offset:16384
  v_mul_f32 v4, v188, v152
  v_mul_f32 v5, v192, v152
  v_fmac_f32 v4, v192, v160
  v_fma_f32 v5, -v188, v160, v5
  v_cvt_pk_bf16_f32 v36, v4, v5
  v_mul_f32 v6, v189, v153
  v_mul_f32 v7, v193, v153
  v_fmac_f32 v6, v193, v161
  v_fma_f32 v7, -v189, v161, v7
  v_cvt_pk_bf16_f32 v37, v6, v7
  v_mul_f32 v4, v190, v154
  v_mul_f32 v5, v194, v154
  v_fmac_f32 v4, v194, v162
  v_fma_f32 v5, -v190, v162, v5
  v_cvt_pk_bf16_f32 v38, v4, v5
  v_mul_f32 v6, v191, v155
  v_mul_f32 v7, v195, v155
  v_fmac_f32 v6, v195, v163
  v_fma_f32 v7, -v191, v163, v7
  v_cvt_pk_bf16_f32 v39, v6, v7
  ds_write_b128 v10, v[36:39] offset:20480
  v_mov_b32 v3, EP_H_ex
  s_mov_b64 exec, 1
  ds_write_b32 v28, v3
  s_mov_b64 exec, -1
  ds_read_b32 v2, v27 offset:16
  s_lshl_b32 s44, s40, 13
  s_lshr_b32 s45, s61, 2
  s_add_u32 s44, s44, s45
  s_add_u32 s44, s44, 6291456
  s_add_u32 s45, s44, 4096
  s_lshl_b32 s4, s38, 8
  s_add_u32 s4, s4, s40
  s_lshl_b32 s4, s4, 4
  s_add_u32 s4, s4, 65536
  s_waitcnt lgkmcnt(0)
  v_cmp_gt_u32 vcc, EP_H_ex, v2
  s_nop 0
  s_cbranch_vccnz L_aslow15
L_agot15:
  ds_read_b128 v[32:35], v60 offset:16384
  ds_read_b128 v[48:51], v60 offset:20480
  ds_read_b128 v[36:39], v60 offset:17408
  ds_read_b128 v[52:55], v60 offset:21504
  ds_read_b128 v[40:43], v60 offset:18432
  ds_read_b128 v[56:59], v60 offset:22528
  ds_read_b128 v[44:47], v60 offset:19456
  ds_read_b128 v[172:175], v60 offset:23552
  s_waitcnt lgkmcnt(7)
  v_mfma_f32_16x16x32_bf16 v[176:179], v[32:35], v[100:103], 0
  v_mfma_f32_16x16x32_bf16 v[180:183], v[32:35], v[104:107], 0
  s_waitcnt lgkmcnt(6)
  v_mfma_f32_16x16x32_bf16 v[188:191], v[48:51], v[100:103], 0
  v_mfma_f32_16x16x32_bf16 v[192:195], v[48:51], v[104:107], 0
  s_waitcnt lgkmcnt(5)
  v_mfma_f32_16x16x32_bf16 v[176:179], v[36:39], v[108:111], v[176:179]
  v_mfma_f32_16x16x32_bf16 v[180:183], v[36:39], v[112:115], v[180:183]
  s_waitcnt lgkmcnt(4)
  v_mfma_f32_16x16x32_bf16 v[188:191], v[52:55], v[108:111], v[188:191]
  v_mfma_f32_16x16x32_bf16 v[192:195], v[52:55], v[112:115], v[192:195]
  s_waitcnt lgkmcnt(3)
  v_mfma_f32_16x16x32_bf16 v[176:179], v[40:43], v[116:119], v[176:179]
  v_mfma_f32_16x16x32_bf16 v[180:183], v[40:43], v[120:123], v[180:183]
  s_waitcnt lgkmcnt(2)
  v_mfma_f32_16x16x32_bf16 v[188:191], v[56:59], v[116:119], v[188:191]
  v_mfma_f32_16x16x32_bf16 v[192:195], v[56:59], v[120:123], v[192:195]
  s_waitcnt lgkmcnt(1)
  v_mfma_f32_16x16x32_bf16 v[176:179], v[44:47], v[124:127], v[176:179]
  v_mfma_f32_16x16x32_bf16 v[180:183], v[44:47], v[128:131], v[180:183]
  s_waitcnt lgkmcnt(0)
  v_mfma_f32_16x16x32_bf16 v[188:191], v[172:175], v[124:127], v[188:191]
  v_mfma_f32_16x16x32_bf16 v[192:195], v[172:175], v[128:131], v[192:195]
  s_setprio 3
  s_nop 2
  v_cvt_pk_bf16_f32 v196, v176, v177
  v_cvt_pk_bf16_f32 v197, v178, v179
  s_nop 0
  v_cvt_pk_bf16_f32 v198, v188, v189
  v_cvt_pk_bf16_f32 v199, v190, v191
  buffer_store_dwordx4 v[196:199], v18, s[32:35], s44 offen sc1
  v_cvt_pk_bf16_f32 v200, v180, v181
  v_cvt_pk_bf16_f32 v201, v182, v183
  v_cvt_pk_bf16_f32 v202, v192, v193
  v_cvt_pk_bf16_f32 v203, v194, v195
  buffer_store_dwordx4 v[200:203], v18, s[32:35], s45 offen sc1
  v_mov_b32 v3, EP_H_cd
  s_mov_b64 exec, 1
  ds_write_b32 v28, v3
  s_mov_b64 exec, -1
  s_and_b32 s58, s38, 1
  s_lshr_b32 s59, s38, 1
  v_lshlrev_b32 v164, 5, v21
  v_and_b32 v165, 1, v17
  v_lshl_add_u32 v164, v165, 4, v164
  v_add_u32 v164, v164, v23
  v_lshlrev_b32 v165, 4, v26
  v_lshl_add_u32 v62, v164, 10, v165
  v_add_u32 v63, 64512, v62
  s_lshl_b32 s54, s36, 8
  s_lshl_b32 s44, s59, 7
  s_add_u32 s54, s54, s44
  s_lshl_b32 s44, s42, 2
  s_add_u32 s54, s54, s44
  s_lshl_b32 s47, s54, 3
  s_add_u32 s47, s47, 98304
  s_lshl_b32 s54, s54, 10
  s_lshl_b32 s44, s41, 7
  s_add_u32 s54, s54, s44
  s_lshl_b32 s44, s58, 6
  s_add_u32 s54, s54, s44
  s_lshr_b32 s44, s36, 1
  s_lshl_b32 s45, s44, 12
  s_lshl_b32 s46, s59, 10
  s_add_u32 s45, s45, s46
  s_lshl_b32 s46, s58, 8
  s_add_u32 s45, s45, s46
  s_add_u32 s45, s45, 65536
  v_and_b32 v164, 1, v17
  v_lshlrev_b32 v164, 9, v164
  v_lshl_add_u32 v164, v21, 11, v164
  v_lshl_add_u32 v164, v16, 4, v164
  v_add_u32 v61, s45, v164
  s_lshl_b32 s55, s44, 10
  s_lshl_b32 s46, s42, 8
  s_add_u32 s55, s55, s46
  s_and_b32 s46, s36, 1
  s_lshl_b32 s46, s46, 7
  s_add_u32 s55, s55, s46
  s_lshl_b32 s56, s59, 2
  s_waitcnt vmcnt(0)
  s_mov_b64 exec, 1
  buffer_store_dword v20, v19, s[32:35], s4 offen sc1
  s_mov_b64 exec, -1
  s_setprio 1
  ds_read_b32 v2, v27 offset:16
  s_waitcnt lgkmcnt(0)
  v_cmp_gt_u32 vcc, EP_H_cd, v2
  s_nop 0
  s_cbranch_vccnz L_aslow16
L_agot16:
  s_lshr_b32 s52, s61, 1
  s_add_u32 m0, s52, 147456
  s_nop 0
  buffer_load_dwordx4 v62, s[8:11], s54 offen offset:0 lds
  buffer_load_dwordx4 v63, s[8:11], s54 offen offset:1024 lds
  s_add_u32 s56, s56, s58
  s_lshl_b32 s46, s56, 17
  s_lshl_b32 s56, s56, 12
  s_add_u32 s56, s56, 65536
  s_add_u32 s55, s55, s46
  s_add_u32 s55, s55, 6291456
  v_lshrrev_b32 v164, 3, v1
  v_lshl_add_u32 v100, v164, 12, v30
  v_add_u32 v101, 31744, v100
  v_add_u32 v102, 63488, v100
  v_add_u32 v103, 95232, v100
  s_lshl_b32 s44, s59, 14
  s_add_u32 s44, s44, 65536
  s_lshl_b32 s45, s59, 6
  v_xor_b32 v164, s45, v31
  v_add_u32 v104, s44, v164
  v_xor_b32 v105, 64, v104
  s_lshl_b32 s44, s41, 6
  s_lshl_b32 s46, s58, 5
  s_add_u32 s44, s44, s46
  v_add_u32 v164, s44, v22
  v_cvt_f32_u32 v168, v164
  v_mul_f32 v168, 0x3b000000, v168
  v_lshl_add_u32 v165, v21, 1, s45
  v_cvt_f32_u32 v165, v165
  v_mul_f32 v169, v168, v165
  v_and_b32 v164, 1, v1
  v_mul_u32_u24 v165, 0x0202, v164
  v_lshl_or_b32 v165, v165, 16, v165
  v_xor_b32 v170, 0x03020100, v165
  v_bfe_u32 v165, v1, 1, 1
  v_xor_b32 v166, v165, v164
  v_lshlrev_b32 v165, 31, v165
  v_lshl_or_b32 v171, v166, 15, v165
  v_fmamk_f32 v164, v168, 0x00000000, v169
  v_cos_f32 v165, v164
  v_sin_f32 v166, v164
  s_nop 0
  v_cvt_pk_bf16_f32 v32, v165, v166
  v_fmamk_f32 v164, v168, 0x3f800000, v169
  v_cos_f32 v165, v164
  v_sin_f32 v166, v164
  v_perm_b32 v167, v32, v32, v170
  v_cvt_pk_bf16_f32 v33, v165, v166
  v_xor_b32 v68, v171, v167
  v_fmamk_f32 v164, v168, 0x40800000, v169
  v_cos_f32 v165, v164
  v_sin_f32 v166, v164
  v_perm_b32 v167, v33, v33, v170
  v_cvt_pk_bf16_f32 v34, v165, v166
  v_xor_b32 v69, v171, v167
  v_fmamk_f32 v164, v168, 0x40a00000, v169
  v_cos_f32 v165, v164
  v_sin_f32 v166, v164
  v_perm_b32 v167, v34, v34, v170
  v_cvt_pk_bf16_f32 v35, v165, v166
  v_xor_b32 v70, v171, v167
  v_fmamk_f32 v164, v168, 0x41000000, v169
  v_cos_f32 v165, v164
  v_sin_f32 v166, v164
  v_perm_b32 v167, v35, v35, v170
  v_cvt_pk_bf16_f32 v36, v165, v166
  v_xor_b32 v71, v171, v167
  v_fmamk_f32 v164, v168, 0x41100000, v169
  v_cos_f32 v165, v164
  v_sin_f32 v166, v164
  v_perm_b32 v167, v36, v36, v170
  v_cvt_pk_bf16_f32 v37, v165, v166
  v_xor_b32 v72, v171, v167
  v_fmamk_f32 v164, v168, 0x41400000, v169
  v_cos_f32 v165, v164
  v_sin_f32 v166, v164
  v_perm_b32 v167, v37, v37, v170
  v_cvt_pk_bf16_f32 v38, v165, v166
  v_xor_b32 v73, v171, v167
  v_fmamk_f32 v164, v168, 0x41500000, v169
  v_cos_f32 v165, v164
  v_sin_f32 v166, v164
  v_perm_b32 v167, v38, v38, v170
  v_cvt_pk_bf16_f32 v39, v165, v166
  v_xor_b32 v74, v171, v167
  v_fmamk_f32 v164, v168, 0x41800000, v169
  v_cos_f32 v165, v164
  v_sin_f32 v166, v164
  v_perm_b32 v167, v39, v39, v170
  v_cvt_pk_bf16_f32 v40, v165, v166
  v_xor_b32 v75, v171, v167
  v_fmamk_f32 v164, v168, 0x41880000, v169
  v_cos_f32 v165, v164
  v_sin_f32 v166, v164
  v_perm_b32 v167, v40, v40, v170
  v_cvt_pk_bf16_f32 v41, v165, v166
  v_xor_b32 v76, v171, v167
  v_fmamk_f32 v164, v168, 0x41a00000, v169
  v_cos_f32 v165, v164
  v_sin_f32 v166, v164
  v_perm_b32 v167, v41, v41, v170
  v_cvt_pk_bf16_f32 v42, v165, v166
  v_xor_b32 v77, v171, v167
  v_fmamk_f32 v164, v168, 0x41a80000, v169
  v_cos_f32 v165, v164
  v_sin_f32 v166, v164
  v_perm_b32 v167, v42, v42, v170
  v_cvt_pk_bf16_f32 v43, v165, v166
  v_xor_b32 v78, v171, v167
  v_fmamk_f32 v164, v168, 0x41c00000, v169
  v_cos_f32 v165, v164
  v_sin_f32 v166, v164
  v_perm_b32 v167, v43, v43, v170
  v_cvt_pk_bf16_f32 v44, v165, v166
  v_xor_b32 v79, v171, v167
  v_fmamk_f32 v164, v168, 0x41c80000, v169
  v_cos_f32 v165, v164
  v_sin_f32 v166, v164
  v_perm_b32 v167, v44, v44, v170
  v_cvt_pk_bf16_f32 v45, v165, v166
  v_xor_b32 v80, v171, v167
  v_fmamk_f32 v164, v168, 0x41e00000, v169
  v_cos_f32 v165, v164
  v_sin_f32 v166, v164
  v_perm_b32 v167, v45, v45, v170
  v_cvt_pk_bf16_f32 v46, v165, v166
  v_xor_b32 v81, v171, v167
  v_fmamk_f32 v164, v168, 0x41e80000, v169
  v_cos_f32 v165, v164
  v_sin_f32 v166, v164
  v_perm_b32 v167, v46, v46, v170
  v_cvt_pk_bf16_f32 v47, v165, v166
  v_xor_b32 v82, v171, v167
  v_fmamk_f32 v164, v168, 0x42000000, v169
  v_cos_f32 v165, v164
  v_sin_f32 v166, v164
  v_perm_b32 v167, v47, v47, v170
  v_cvt_pk_bf16_f32 v48, v165, v166
  v_xor_b32 v83, v171, v167
  v_fmamk_f32 v164, v168, 0x42040000, v169
  v_cos_f32 v165, v164
  v_sin_f32 v166, v164
  v_perm_b32 v167, v48, v48, v170
  v_cvt_pk_bf16_f32 v49, v165, v166
  v_xor_b32 v84, v171, v167
  v_fmamk_f32 v164, v168, 0x42100000, v169
  v_cos_f32 v165, v164
  v_sin_f32 v166, v164
  v_perm_b32 v167, v49, v49, v170
  v_cvt_pk_bf16_f32 v50, v165, v166
  v_xor_b32 v85, v171, v167
  v_fmamk_f32 v164, v168, 0x42140000, v169
  v_cos_f32 v165, v164
  v_sin_f32 v166, v164
  v_perm_b32 v167, v50, v50, v170
  v_cvt_pk_bf16_f32 v51, v165, v166
  v_xor_b32 v86, v171, v167
  v_fmamk_f32 v164, v168, 0x42200000, v169
  v_cos_f32 v165, v164
  v_sin_f32 v166, v164
  v_perm_b32 v167, v51, v51, v170
  v_cvt_pk_bf16_f32 v52, v165, v166
  v_xor_b32 v87, v171, v167
  v_fmamk_f32 v164, v168, 0x42240000, v169
  v_cos_f32 v165, v164
  v_sin_f32 v166, v164
  v_perm_b32 v167, v52, v52, v170
  v_cvt_pk_bf16_f32 v53, v165, v166
  v_xor_b32 v88, v171, v167
  v_fmamk_f32 v164, v168, 0x42300000, v169
  v_cos_f32 v165, v164
  v_sin_f32 v166, v164
  v_perm_b32 v167, v53, v53, v170
  v_cvt_pk_bf16_f32 v54, v165, v166
  v_xor_b32 v89, v171, v167
  v_fmamk_f32 v164, v168, 0x42340000, v169
  v_cos_f32 v165, v164
  v_sin_f32 v166, v164
  v_perm_b32 v167, v54, v54, v170
  v_cvt_pk_bf16_f32 v55, v165, v166
  v_xor_b32 v90, v171, v167
  v_fmamk_f32 v164, v168, 0x42400000, v169
  v_cos_f32 v165, v164
  v_sin_f32 v166, v164
  v_perm_b32 v167, v55, v55, v170
  v_cvt_pk_bf16_f32 v56, v165, v166
  v_xor_b32 v91, v171, v167
  v_fmamk_f32 v164, v168, 0x42440000, v169
  v_cos_f32 v165, v164
  v_sin_f32 v166, v164
  v_perm_b32 v167, v56, v56, v170
  v_cvt_pk_bf16_f32 v57, v165, v166
  v_xor_b32 v92, v171, v167
  v_fmamk_f32 v164, v168, 0x42500000, v169
  v_cos_f32 v165, v164
  v_sin_f32 v166, v164
  v_perm_b32 v167, v57, v57, v170
  v_cvt_pk_bf16_f32 v58, v165, v166
  v_xor_b32 v93, v171, v167
  v_fmamk_f32 v164, v168, 0x42540000, v169
  v_cos_f32 v165, v164
  v_sin_f32 v166, v164
  v_perm_b32 v167, v58, v58, v170
  v_cvt_pk_bf16_f32 v59, v165, v166
  v_xor_b32 v94, v171, v167
  v_fmamk_f32 v164, v168, 0x42600000, v169
  v_cos_f32 v165, v164
  v_sin_f32 v166, v164
  v_perm_b32 v167, v59, v59, v170
  v_cvt_pk_bf16_f32 v64, v165, v166
  v_xor_b32 v95, v171, v167
  v_fmamk_f32 v164, v168, 0x42640000, v169
  v_cos_f32 v165, v164
  v_sin_f32 v166, v164
  v_perm_b32 v167, v64, v64, v170
  v_cvt_pk_bf16_f32 v65, v165, v166
  v_xor_b32 v96, v171, v167
  v_fmamk_f32 v164, v168, 0x42700000, v169
  v_cos_f32 v165, v164
  v_sin_f32 v166, v164
  v_perm_b32 v167, v65, v65, v170
  v_cvt_pk_bf16_f32 v66, v165, v166
  v_xor_b32 v97, v171, v167
  v_fmamk_f32 v164, v168, 0x42740000, v169
  v_cos_f32 v165, v164
  v_sin_f32 v166, v164
  v_perm_b32 v167, v66, v66, v170
  v_cvt_pk_bf16_f32 v67, v165, v166
  v_xor_b32 v98, v171, v167
  v_perm_b32 v167, v67, v67, v170
  v_xor_b32 v99, v171, v167
  v_and_b32 v164, 1, v1
  v_lshlrev_b32 v164, 31, v164
  v_xor_b32 v164, 0xbf803f80, v164
  s_sub_u32 s48, s59, 1
  s_mov_b32 s49, 0
  v_cndmask_b32 v32, v32, v164, s[48:49]
  s_setprio 3
  s_add_u32 s60, s60, 128
  s_waitcnt vmcnt(0)
  v_mov_b32 v3, EP_H_xt
  s_mov_b64 exec, 1
  ds_write_b32 v28, v3
  s_mov_b64 exec, -1
  ds_read_b32 v2, v27 offset:0
  s_waitcnt lgkmcnt(0)
  v_cmp_gt_u32 vcc, EP_G_t3, v2
  s_nop 0
  s_cbranch_vccnz L_aslow17
L_agot17:
  buffer_load_dword v184, v61, s[32:35], 0 offen sc1
  ds_read_b32 v2, v27 offset:0
  s_waitcnt lgkmcnt(0)
  v_cmp_gt_u32 vcc, EP_G_s01, v2
  s_nop 0
  s_cbranch_vccnz L_aslow18
L_agot18:
  s_waitcnt vmcnt(0)
  v_cmp_ne_u32 vcc, s39, v184
  s_nop 0
  s_cbranch_vccnz L_slow19
L_got19:
  s_add_u32 m0, s56, 0
  s_add_u32 s52, s55, 0
  buffer_load_dwordx4 v100, s[32:35], s52 offen offset:0 sc1 lds
  buffer_load_dwordx4 v101, s[32:35], s52 offen offset:1024 sc1 lds
  buffer_load_dwordx4 v102, s[32:35], s52 offen offset:2048 sc1 lds
  buffer_load_dwordx4 v103, s[32:35], s52 offen offset:3072 sc1 lds
  s_add_u32 m0, s56, 8192
  s_add_u32 s52, s55, 262144
  buffer_load_dwordx4 v100, s[32:35], s52 offen offset:0 sc1 lds
  buffer_load_dwordx4 v101, s[32:35], s52 offen offset:1024 sc1 lds
  buffer_load_dwordx4 v102, s[32:35], s52 offen offset:2048 sc1 lds
  buffer_load_dwordx4 v103, s[32:35], s52 offen offset:3072 sc1 lds
  s_add_u32 m0, s56, 32768
  s_add_u32 s52, s55, 1048576
  buffer_load_dwordx4 v100, s[32:35], s52 offen offset:0 sc1 lds
  buffer_load_dwordx4 v101, s[32:35], s52 offen offset:1024 sc1 lds
  buffer_load_dwordx4 v102, s[32:35], s52 offen offset:2048 sc1 lds
  buffer_load_dwordx4 v103, s[32:35], s52 offen offset:3072 sc1 lds
  s_add_u32 m0, s56, 40960
  s_add_u32 s52, s55, 1310720
  buffer_load_dwordx4 v100, s[32:35], s52 offen offset:0 sc1 lds
  buffer_load_dwordx4 v101, s[32:35], s52 offen offset:1024 sc1 lds
  buffer_load_dwordx4 v102, s[32:35], s52 offen offset:2048 sc1 lds
  buffer_load_dwordx4 v103, s[32:35], s52 offen offset:3072 sc1 lds
  v_add_u32 v106, s61, v60
  v_add_u32 v107, s56, v18
  s_waitcnt vmcnt(12)
  v_mov_b32 v3, EP_H_y0
  s_mov_b64 exec, 1
  ds_write_b32 v28, v3
  s_mov_b64 exec, -1
  ds_read_b32 v2, v27 offset:16
  s_waitcnt lgkmcnt(0)
  v_cmp_gt_u32 vcc, EP_H_y0, v2
  s_nop 0
  s_cbranch_vccnz L_aslow20
L_agot20:
  ds_read_b64_tr_b16 v[144:145], v105 offset:0
  ds_read_b64_tr_b16 v[146:147], v105 offset:1024
  ds_read_b64_tr_b16 v[140:141], v104 offset:0
  ds_read_b64_tr_b16 v[142:143], v104 offset:1024
  ds_read_b64_tr_b16 v[152:153], v105 offset:2048
  ds_read_b64_tr_b16 v[154:155], v105 offset:3072
  ds_read_b64_tr_b16 v[148:149], v104 offset:2048
  ds_read_b64_tr_b16 v[150:151], v104 offset:3072
  ds_read_b64_tr_b16 v[160:161], v105 offset:4096
  ds_read_b64_tr_b16 v[162:163], v105 offset:5120
  ds_read_b64_tr_b16 v[156:157], v104 offset:4096
  ds_read_b64_tr_b16 v[158:159], v104 offset:5120
  ds_read_b64_tr_b16 v[176:177], v105 offset:6144
  ds_read_b64_tr_b16 v[178:179], v105 offset:7168
  ds_read_b64_tr_b16 v[172:173], v104 offset:6144
  ds_read_b64_tr_b16 v[174:175], v104 offset:7168
  s_waitcnt vmcnt(8)
  v_mov_b32 v3, EP_H_y1
  s_mov_b64 exec, 1
  ds_write_b32 v28, v3
  s_mov_b64 exec, -1
  ds_read_b32 v2, v27 offset:16
  s_waitcnt lgkmcnt(15)
  v_mfma_f32_32x32x16_bf16 v[124:139], v[32:35], v[144:147], 0
  s_waitcnt lgkmcnt(14)
  v_mfma_f32_32x32x16_bf16 v[108:123], v[32:35], v[140:143], 0
  s_waitcnt lgkmcnt(12)
  v_mfma_f32_32x32x16_bf16 v[124:139], v[36:39], v[152:155], v[124:139]
  s_waitcnt lgkmcnt(10)
  v_mfma_f32_32x32x16_bf16 v[108:123], v[36:39], v[148:151], v[108:123]
  s_waitcnt lgkmcnt(0)
  v_cmp_gt_u32 vcc, EP_H_y1, v2
  s_nop 0
  s_cbranch_vccnz L_aslow21
L_agot21:
  ds_read_b64_tr_b16 v[188:189], v105 offset:8192
  ds_read_b64_tr_b16 v[190:191], v105 offset:9216
  ds_read_b64_tr_b16 v[180:181], v104 offset:8192
  ds_read_b64_tr_b16 v[182:183], v104 offset:9216
  v_mfma_f32_32x32x16_bf16 v[124:139], v[40:43], v[160:163], v[124:139]
  ds_read_b64_tr_b16 v[196:197], v105 offset:10240
  ds_read_b64_tr_b16 v[198:199], v105 offset:11264
  ds_read_b64_tr_b16 v[192:193], v104 offset:10240
  ds_read_b64_tr_b16 v[194:195], v104 offset:11264
  v_mfma_f32_32x32x16_bf16 v[108:123], v[40:43], v[156:159], v[108:123]
  ds_read_b64_tr_b16 v[204:205], v105 offset:12288
  ds_read_b64_tr_b16 v[206:207], v105 offset:13312
  ds_read_b64_tr_b16 v[200:201], v104 offset:12288
  ds_read_b64_tr_b16 v[202:203], v104 offset:13312
  v_mfma_f32_32x32x16_bf16 v[124:139], v[44:47], v[176:179], v[124:139]
  ds_read_b64_tr_b16 v[212:213], v105 offset:14336
  ds_read_b64_tr_b16 v[214:215], v105 offset:15360
  ds_read_b64_tr_b16 v[208:209], v104 offset:14336
  ds_read_b64_tr_b16 v[210:211], v104 offset:15360
  v_mfma_f32_32x32x16_bf16 v[108:123], v[44:47], v[172:175], v[108:123]
  s_waitcnt vmcnt(4)
  v_mov_b32 v3, EP_H_y2
  s_mov_b64 exec, 1
  ds_write_b32 v28, v3
  s_mov_b64 exec, -1
  ds_read_b32 v2, v27 offset:16
  s_waitcnt lgkmcnt(15)
  v_mfma_f32_32x32x16_bf16 v[124:139], v[48:51], v[188:191], v[124:139]
  s_waitcnt lgkmcnt(14)
  v_mfma_f32_32x32x16_bf16 v[108:123], v[48:51], v[180:183], v[108:123]
  s_waitcnt lgkmcnt(12)
  v_mfma_f32_32x32x16_bf16 v[124:139], v[52:55], v[196:199], v[124:139]
  s_waitcnt lgkmcnt(10)
  v_mfma_f32_32x32x16_bf16 v[108:123], v[52:55], v[192:195], v[108:123]
  s_waitcnt lgkmcnt(0)
  v_cmp_gt_u32 vcc, EP_H_y2, v2
  s_nop 0
  s_cbranch_vccnz L_aslow22
L_agot22:
  ds_read_b64_tr_b16 v[144:145], v105 offset:32768
  ds_read_b64_tr_b16 v[146:147], v105 offset:33792
  ds_read_b64_tr_b16 v[140:141], v104 offset:32768
  ds_read_b64_tr_b16 v[142:143], v104 offset:33792
  v_mfma_f32_32x32x16_bf16 v[124:139], v[56:59], v[204:207], v[124:139]
  ds_read_b64_tr_b16 v[152:153], v105 offset:34816
  ds_read_b64_tr_b16 v[154:155], v105 offset:35840
  ds_read_b64_tr_b16 v[148:149], v104 offset:34816
  ds_read_b64_tr_b16 v[150:151], v104 offset:35840
  v_mfma_f32_32x32x16_bf16 v[108:123], v[56:59], v[200:203], v[108:123]
  ds_read_b64_tr_b16 v[160:161], v105 offset:36864
  ds_read_b64_tr_b16 v[162:163], v105 offset:37888
  ds_read_b64_tr_b16 v[156:157], v104 offset:36864
  ds_read_b64_tr_b16 v[158:159], v104 offset:37888
  v_mfma_f32_32x32x16_bf16 v[124:139], v[64:67], v[212:215], v[124:139]
  ds_read_b64_tr_b16 v[176:177], v105 offset:38912
  ds_read_b64_tr_b16 v[178:179], v105 offset:39936
  ds_read_b64_tr_b16 v[172:173], v104 offset:38912
  ds_read_b64_tr_b16 v[174:175], v104 offset:39936
  v_mfma_f32_32x32x16_bf16 v[108:123], v[64:67], v[208:211], v[108:123]
  s_waitcnt vmcnt(0)
  v_mov_b32 v3, EP_H_y3
  s_mov_b64 exec, 1
  ds_write_b32 v28, v3
  s_mov_b64 exec, -1
  ds_read_b32 v2, v27 offset:16
  s_waitcnt lgkmcnt(15)
  v_mfma_f32_32x32x16_bf16 v[124:139], v[68:71], v[144:147], v[124:139]
  s_waitcnt lgkmcnt(14)
  v_mfma_f32_32x32x16_bf16 v[108:123], v[68:71], v[140:143], v[108:123]
  s_waitcnt lgkmcnt(12)
  v_mfma_f32_32x32x16_bf16 v[124:139], v[72:75], v[152:155], v[124:139]
  s_waitcnt lgkmcnt(10)
  v_mfma_f32_32x32x16_bf16 v[108:123], v[72:75], v[148:151], v[108:123]
  s_waitcnt lgkmcnt(0)
  v_cmp_gt_u32 vcc, EP_H_y3, v2
  s_nop 0
  s_cbranch_vccnz L_aslow23
L_agot23:
  ds_read_b64_tr_b16 v[188:189], v105 offset:40960
  ds_read_b64_tr_b16 v[190:191], v105 offset:41984
  ds_read_b64_tr_b16 v[180:181], v104 offset:40960
  ds_read_b64_tr_b16 v[182:183], v104 offset:41984
  v_mfma_f32_32x32x16_bf16 v[124:139], v[76:79], v[160:163], v[124:139]
  ds_read_b64_tr_b16 v[196:197], v105 offset:43008
  ds_read_b64_tr_b16 v[198:199], v105 offset:44032
  ds_read_b64_tr_b16 v[192:193], v104 offset:43008
  ds_read_b64_tr_b16 v[194:195], v104 offset:44032
  v_mfma_f32_32x32x16_bf16 v[108:123], v[76:79], v[156:159], v[108:123]
  ds_read_b64_tr_b16 v[204:205], v105 offset:45056
  ds_read_b64_tr_b16 v[206:207], v105 offset:46080
  ds_read_b64_tr_b16 v[200:201], v104 offset:45056
  ds_read_b64_tr_b16 v[202:203], v104 offset:46080
  v_mfma_f32_32x32x16_bf16 v[124:139], v[80:83], v[176:179], v[124:139]
  ds_read_b64_tr_b16 v[212:213], v105 offset:47104
  ds_read_b64_tr_b16 v[214:215], v105 offset:48128
  ds_read_b64_tr_b16 v[208:209], v104 offset:47104
  ds_read_b64_tr_b16 v[210:211], v104 offset:48128
  v_mfma_f32_32x32x16_bf16 v[108:123], v[80:83], v[172:175], v[108:123]
  s_waitcnt lgkmcnt(14)
  v_mfma_f32_32x32x16_bf16 v[124:139], v[84:87], v[188:191], v[124:139]
  s_waitcnt lgkmcnt(12)
  v_mfma_f32_32x32x16_bf16 v[108:123], v[84:87], v[180:183], v[108:123]
  s_waitcnt lgkmcnt(10)
  v_mfma_f32_32x32x16_bf16 v[124:139], v[88:91], v[196:199], v[124:139]
  s_waitcnt lgkmcnt(8)
  v_mfma_f32_32x32x16_bf16 v[108:123], v[88:91], v[192:195], v[108:123]
  s_waitcnt lgkmcnt(6)
  v_mfma_f32_32x32x16_bf16 v[124:139], v[92:95], v[204:207], v[124:139]
  s_waitcnt lgkmcnt(4)
  v_mfma_f32_32x32x16_bf16 v[108:123], v[92:95], v[200:203], v[108:123]
  s_waitcnt lgkmcnt(2)
  v_mfma_f32_32x32x16_bf16 v[124:139], v[96:99], v[212:215], v[124:139]
  s_waitcnt lgkmcnt(0)
  v_mfma_f32_32x32x16_bf16 v[108:123], v[96:99], v[208:211], v[108:123]
  s_nop 9
  ds_write_b128 v107, v[124:127] offset:0
  ds_write_b128 v107, v[128:131] offset:1024
  ds_write_b128 v107, v[132:135] offset:2048
  ds_write_b128 v107, v[136:139] offset:3072
  ds_write_b128 v106, v[108:111] offset:0
  ds_write_b128 v106, v[112:115] offset:1024
  ds_write_b128 v106, v[116:119] offset:2048
  ds_write_b128 v106, v[120:123] offset:3072
  v_mov_b32 v3, EP_H_done
  s_mov_b64 exec, 1
  ds_write_b32 v28, v3
  s_mov_b64 exec, -1
  s_endpgm
L_aslow1:
  s_mov_b32 s43, 0
L_aspin1:
  s_sleep 1
  ds_read_b32 v2, v27 offset:0
  s_waitcnt lgkmcnt(0)
  v_cmp_gt_u32 vcc, EP_G_rel0, v2
  s_nop 0
  s_cbranch_vccz L_agot1
  s_add_u32 s43, s43, 1
  s_cmp_lt_u32 s43, 0x400000
  s_cbranch_scc1 L_aspin1
  s_branch L_agot1
L_aslow2:
  s_mov_b32 s43, 0
L_aspin2:
  s_sleep 1
  ds_read_b32 v2, v27 offset:0
  s_waitcnt lgkmcnt(0)
  v_cmp_gt_u32 vcc, EP_G_rel1, v2
  s_nop 0
  s_cbranch_vccz L_agot2
  s_add_u32 s43, s43, 1
  s_cmp_lt_u32 s43, 0x400000
  s_cbranch_scc1 L_aspin2
  s_branch L_agot2
L_slow3:
  s_mov_b32 s43, 0
L_spin3:
  s_mov_b64 exec, vcc
  s_sleep 3
  buffer_load_dwordx2 v[176:177], v180, s[32:35], 0 offen sc1
  s_waitcnt vmcnt(0)
  v_cmp_ne_u32 vcc, s39, v177
  s_mov_b64 exec, -1
  s_cbranch_vccz L_got3
  s_add_u32 s43, s43, 1
  s_cmp_lt_u32 s43, 200000
  s_cbranch_scc1 L_spin3
  s_branch L_got3
L_xcslow4:
  s_sleep 8
  buffer_load_dword v178, v182, s[32:35], 0 offen sc1
  s_waitcnt vmcnt(0) lgkmcnt(0)
  s_add_u32 s43, s43, 1
  s_cmp_lt_u32 s43, 100000
  s_cbranch_scc1 L_xc4
  s_branch L_xcgo4
L_aslow5:
  s_mov_b32 s43, 0
L_aspin5:
  s_sleep 1
  ds_read_b32 v2, v27 offset:0
  s_waitcnt lgkmcnt(0)
  v_cmp_gt_u32 vcc, EP_G_rel2, v2
  s_nop 0
  s_cbranch_vccz L_agot5
  s_add_u32 s43, s43, 1
  s_cmp_lt_u32 s43, 0x400000
  s_cbranch_scc1 L_aspin5
  s_branch L_agot5
L_aslow6:
  s_mov_b32 s43, 0
L_aspin6:
  s_sleep 1
  ds_read_b32 v2, v27 offset:0
  s_waitcnt lgkmcnt(0)
  v_cmp_gt_u32 vcc, EP_G_rel3, v2
  s_nop 0
  s_cbranch_vccz L_agot6
  s_add_u32 s43, s43, 1
  s_cmp_lt_u32 s43, 0x400000
  s_cbranch_scc1 L_aspin6
  s_branch L_agot6
L_aslow7:
  s_mov_b32 s43, 0
L_aspin7:
  s_sleep 1
  ds_read_b32 v2, v27 offset:0
  s_waitcnt lgkmcnt(0)
  v_cmp_gt_u32 vcc, EP_G_rel4, v2
  s_nop 0
  s_cbranch_vccz L_agot7
  s_add_u32 s43, s43, 1
  s_cmp_lt_u32 s43, 0x400000
  s_cbranch_scc1 L_aspin7
  s_branch L_agot7
L_aslow8:
  s_mov_b32 s43, 0
L_aspin8:
  s_sleep 1
  ds_read_b32 v2, v27 offset:0
  s_waitcnt lgkmcnt(0)
  v_cmp_gt_u32 vcc, EP_G_rel5, v2
  s_nop 0
  s_cbranch_vccz L_agot8
  s_add_u32 s43, s43, 1
  s_cmp_lt_u32 s43, 0x400000
  s_cbranch_scc1 L_aspin8
  s_branch L_agot8
L_slow9:
  s_mov_b32 s43, 0
L_spin9:
  s_mov_b64 exec, vcc
  s_sleep 3
  buffer_load_dword v184, v19, s[32:35], s60 offen sc1
  s_waitcnt vmcnt(0)
  v_cmp_ne_u32 vcc, s39, v184
  s_mov_b64 exec, -1
  s_cbranch_vccz L_got9
  s_add_u32 s43, s43, 1
  s_cmp_lt_u32 s43, 200000
  s_cbranch_scc1 L_spin9
  s_branch L_got9
L_aslow10:
  s_mov_b32 s43, 0
L_aspin10:
  s_sleep 1
  ds_read_b32 v2, v27 offset:0
  s_waitcnt lgkmcnt(0)
  v_cmp_gt_u32 vcc, EP_G_rel6, v2
  s_nop 0
  s_cbranch_vccz L_agot10
  s_add_u32 s43, s43, 1
  s_cmp_lt_u32 s43, 0x400000
  s_cbranch_scc1 L_aspin10
  s_branch L_agot10
L_aslow11:
  s_mov_b32 s43, 0
L_aspin11:
  s_sleep 1
  ds_read_b32 v2, v27 offset:16
  s_waitcnt lgkmcnt(0)
  v_cmp_gt_u32 vcc, EP_H_xc, v2
  s_nop 0
  s_cbranch_vccz L_agot11
  s_add_u32 s43, s43, 1
  s_cmp_lt_u32 s43, 0x400000
  s_cbranch_scc1 L_aspin11
  s_branch L_agot11
L_special:
  v_mov_b32 v3, EP_H_fr
  s_mov_b64 exec, 1
  ds_write_b32 v28, v3
  s_mov_b64 exec, -1
  v_lshlrev_b32 v164, 3, v66
  v_add_u32 v164, 131072, v164
  s_add_u32 s44, s62, 98304
  v_add_u32 v165, s44, v18
  ds_read_b32 v2, v27 offset:0
  s_waitcnt lgkmcnt(0)
  v_cmp_gt_u32 vcc, EP_G_cs, v2
  s_nop 0
  s_cbranch_vccnz L_aslow12
L_agot12:
  ds_read_b128 v[32:35], v165 offset:0
  ds_read_b128 v[36:39], v165 offset:1024
  ds_read_b128 v[40:43], v165 offset:2048
  ds_read_b128 v[44:47], v165 offset:3072
  ds_read_b128 v[48:51], v165 offset:4096
  ds_read_b128 v[52:55], v165 offset:5120
  ds_read_b128 v[56:59], v165 offset:6144
  ds_read_b128 v[172:175], v165 offset:7168
  ds_read_b32 v2, v27 offset:16
  s_waitcnt lgkmcnt(0)
  v_cmp_gt_u32 vcc, EP_H_fr, v2
  s_nop 0
  s_cbranch_vccnz L_aslow13
L_agot13:
  ds_write2_b32 v164, v176, v180 offset0:0 offset1:1
  v_add_u32 v164, 512, v164
  ds_write2_b32 v164, v177, v181 offset0:0 offset1:1
  v_add_u32 v164, 512, v164
  ds_write2_b32 v164, v178, v182 offset0:0 offset1:1
  v_add_u32 v164, 512, v164
  ds_write2_b32 v164, v179, v183 offset0:0 offset1:1
  v_add_u32 v164, 6656, v164
  ds_write2_b32 v164, v188, v192 offset0:0 offset1:1
  v_add_u32 v164, 512, v164
  ds_write2_b32 v164, v189, v193 offset0:0 offset1:1
  v_add_u32 v164, 512, v164
  ds_write2_b32 v164, v190, v194 offset0:0 offset1:1
  v_add_u32 v164, 512, v164
  ds_write2_b32 v164, v191, v195 offset0:0 offset1:1
  v_mov_b32 v3, EP_H_sp1
  s_mov_b64 exec, 1
  ds_write_b32 v28, v3
  s_mov_b64 exec, -1
  v_sub_u32 v204, 2048, v66
  v_and_b32 v204, 2047, v204
  v_lshlrev_b32 v204, 3, v204
  v_add_u32 v204, 131072, v204
  v_sub_u32 v205, 1984, v66
  v_and_b32 v205, 2047, v205
  v_lshlrev_b32 v205, 3, v205
  v_add_u32 v205, 131072, v205
  v_sub_u32 v206, 1920, v66
  v_and_b32 v206, 2047, v206
  v_lshlrev_b32 v206, 3, v206
  v_add_u32 v206, 131072, v206
  v_sub_u32 v207, 1856, v66
  v_and_b32 v207, 2047, v207
  v_lshlrev_b32 v207, 3, v207
  v_add_u32 v207, 131072, v207
  v_sub_u32 v208, 1024, v66
  v_and_b32 v208, 2047, v208
  v_lshlrev_b32 v208, 3, v208
  v_add_u32 v208, 131072, v208
  v_sub_u32 v209, 960, v66
  v_and_b32 v209, 2047, v209
  v_lshlrev_b32 v209, 3, v209
  v_add_u32 v209, 131072, v209
  v_sub_u32 v210, 896, v66
  v_and_b32 v210, 2047, v210
  v_lshlrev_b32 v210, 3, v210
  v_add_u32 v210, 131072, v210
  v_sub_u32 v211, 832, v66
  v_and_b32 v211, 2047, v211
  v_lshlrev_b32 v211, 3, v211
  v_add_u32 v211, 131072, v211
  ds_read_b32 v2, v27 offset:16
  s_waitcnt lgkmcnt(0)
  v_cmp_gt_u32 vcc, EP_H_sp1, v2
  s_nop 0
  s_cbranch_vccnz L_aslow14
L_agot14:
  ds_read_b64 v[132:133], v204
  ds_read_b64 v[134:135], v205
  ds_read_b64 v[136:137], v206
  ds_read_b64 v[138:139], v207
  ds_read_b64 v[140:141], v208
  ds_read_b64 v[142:143], v209
  ds_read_b64 v[144:145], v210
  ds_read_b64 v[146:147], v211
  v_mul_f32 v204, v32, v176
  v_fma_f32 v204, -v33, v180, v204
  v_mul_f32 v176, v33, v176
  v_fmac_f32 v176, v32, v180
  v_mul_f32 v205, v36, v177
  v_fma_f32 v205, -v37, v181, v205
  v_mul_f32 v177, v37, v177
  v_fmac_f32 v177, v36, v181
  v_mul_f32 v206, v40, v178
  v_fma_f32 v206, -v41, v182, v206
  v_mul_f32 v178, v41, v178
  v_fmac_f32 v178, v40, v182
  v_mul_f32 v207, v44, v179
  v_fma_f32 v207, -v45, v183, v207
  v_mul_f32 v179, v45, v179
  v_fmac_f32 v179, v44, v183
  v_mul_f32 v208, v48, v188
  v_fma_f32 v208, -v49, v192, v208
  v_mul_f32 v188, v49, v188
  v_fmac_f32 v188, v48, v192
  v_mul_f32 v209, v52, v189
  v_fma_f32 v209, -v53, v193, v209
  v_mul_f32 v189, v53, v189
  v_fmac_f32 v189, v52, v193
  v_mul_f32 v210, v56, v190
  v_fma_f32 v210, -v57, v194, v210
  v_mul_f32 v190, v57, v190
  v_fmac_f32 v190, v56, v194
  v_mul_f32 v211, v172, v191
  v_fma_f32 v211, -v173, v195, v211
  v_mul_f32 v191, v173, v191
  v_fmac_f32 v191, v172, v195
  s_waitcnt lgkmcnt(7)
  v_fmac_f32 v204, v34, v132
  v_fmac_f32 v204, v35, v133
  v_fmac_f32 v176, v35, v132
  v_fma_f32 v176, -v34, v133, v176
  v_cvt_pk_bf16_f32 v196, v204, -v176
  s_waitcnt lgkmcnt(6)
  v_fmac_f32 v205, v38, v134
  v_fmac_f32 v205, v39, v135
  v_fmac_f32 v177, v39, v134
  v_fma_f32 v177, -v38, v135, v177
  v_cvt_pk_bf16_f32 v197, v205, -v177
  s_waitcnt lgkmcnt(5)
  v_fmac_f32 v206, v42, v136
  v_fmac_f32 v206, v43, v137
  v_fmac_f32 v178, v43, v136
  v_fma_f32 v178, -v42, v137, v178
  v_cvt_pk_bf16_f32 v198, v206, -v178
  s_waitcnt lgkmcnt(4)
  v_fmac_f32 v207, v46, v138
  v_fmac_f32 v207, v47, v139
  v_fmac_f32 v179, v47, v138
  v_fma_f32 v179, -v46, v139, v179
  v_cvt_pk_bf16_f32 v199, v207, -v179
  s_waitcnt lgkmcnt(3)
  v_fmac_f32 v208, v50, v140
  v_fmac_f32 v208, v51, v141
  v_fmac_f32 v188, v51, v140
  v_fma_f32 v188, -v50, v141, v188
  v_cvt_pk_bf16_f32 v200, v208, -v188
  s_waitcnt lgkmcnt(2)
  v_fmac_f32 v209, v54, v142
  v_fmac_f32 v209, v55, v143
  v_fmac_f32 v189, v55, v142
  v_fma_f32 v189, -v54, v143, v189
  v_cvt_pk_bf16_f32 v201, v209, -v189
  s_waitcnt lgkmcnt(1)
  v_fmac_f32 v210, v58, v144
  v_fmac_f32 v210, v59, v145
  v_fmac_f32 v190, v59, v144
  v_fma_f32 v190, -v58, v145, v190
  v_cvt_pk_bf16_f32 v202, v210, -v190
  s_waitcnt lgkmcnt(0)
  v_fmac_f32 v211, v174, v146
  v_fmac_f32 v211, v175, v147
  v_fmac_f32 v191, v175, v146
  v_fma_f32 v191, -v174, v147, v191
  v_cvt_pk_bf16_f32 v203, v211, -v191
  s_waitcnt lgkmcnt(0)
  s_nop 1
  s_branch L_special_done
L_aslow12:
  s_mov_b32 s43, 0
L_aspin12:
  s_sleep 1
  ds_read_b32 v2, v27 offset:0
  s_waitcnt lgkmcnt(0)
  v_cmp_gt_u32 vcc, EP_G_cs, v2
  s_nop 0
  s_cbranch_vccz L_agot12
  s_add_u32 s43, s43, 1
  s_cmp_lt_u32 s43, 0x400000
  s_cbranch_scc1 L_aspin12
  s_branch L_agot12
L_aslow13:
  s_mov_b32 s43, 0
L_aspin13:
  s_sleep 1
  ds_read_b32 v2, v27 offset:16
  s_waitcnt lgkmcnt(0)
  v_cmp_gt_u32 vcc, EP_H_fr, v2
  s_nop 0
  s_cbranch_vccz L_agot13
  s_add_u32 s43, s43, 1
  s_cmp_lt_u32 s43, 0x400000
  s_cbranch_scc1 L_aspin13
  s_branch L_agot13
L_aslow14:
  s_mov_b32 s43, 0
L_aspin14:
  s_sleep 1
  ds_read_b32 v2, v27 offset:16
  s_waitcnt lgkmcnt(0)
  v_cmp_gt_u32 vcc, EP_H_sp1, v2
  s_nop 0
  s_cbranch_vccz L_agot14
  s_add_u32 s43, s43, 1
  s_cmp_lt_u32 s43, 0x400000
  s_cbranch_scc1 L_aspin14
  s_branch L_agot14
L_aslow15:
  s_mov_b32 s43, 0
L_aspin15:
  s_sleep 1
  ds_read_b32 v2, v27 offset:16
  s_waitcnt lgkmcnt(0)
  v_cmp_gt_u32 vcc, EP_H_ex, v2
  s_nop 0
  s_cbranch_vccz L_agot15
  s_add_u32 s43, s43, 1
  s_cmp_lt_u32 s43, 0x400000
  s_cbranch_scc1 L_aspin15
  s_branch L_agot15
L_aslow16:
  s_mov_b32 s43, 0
L_aspin16:
  s_sleep 1
  ds_read_b32 v2, v27 offset:16
  s_waitcnt lgkmcnt(0)
  v_cmp_gt_u32 vcc, EP_H_cd, v2
  s_nop 0
  s_cbranch_vccz L_agot16
  s_add_u32 s43, s43, 1
  s_cmp_lt_u32 s43, 0x400000
  s_cbranch_scc1 L_aspin16
  s_branch L_agot16
L_aslow17:
  s_mov_b32 s43, 0
L_aspin17:
  s_sleep 1
  ds_read_b32 v2, v27 offset:0
  s_waitcnt lgkmcnt(0)
  v_cmp_gt_u32 vcc, EP_G_t3, v2
  s_nop 0
  s_cbranch_vccz L_agot17
  s_add_u32 s43, s43, 1
  s_cmp_lt_u32 s43, 0x400000
  s_cbranch_scc1 L_aspin17
  s_branch L_agot17
L_aslow18:
  s_mov_b32 s43, 0
L_aspin18:
  s_sleep 1
  ds_read_b32 v2, v27 offset:0
  s_waitcnt lgkmcnt(0)
  v_cmp_gt_u32 vcc, EP_G_s01, v2
  s_nop 0
  s_cbranch_vccz L_agot18
  s_add_u32 s43, s43, 1
  s_cmp_lt_u32 s43, 0x400000
  s_cbranch_scc1 L_aspin18
  s_branch L_agot18
L_slow19:
  s_mov_b32 s43, 0
L_spin19:
  s_mov_b64 exec, vcc
  s_sleep 3
  buffer_load_dword v184, v61, s[32:35], 0 offen sc1
  s_waitcnt vmcnt(0)
  v_cmp_ne_u32 vcc, s39, v184
  s_mov_b64 exec, -1
  s_cbranch_vccz L_got19
  s_add_u32 s43, s43, 1
  s_cmp_lt_u32 s43, 200000
  s_cbranch_scc1 L_spin19
  s_branch L_got19
L_aslow20:
  s_mov_b32 s43, 0
L_aspin20:
  s_sleep 1
  ds_read_b32 v2, v27 offset:16
  s_waitcnt lgkmcnt(0)
  v_cmp_gt_u32 vcc, EP_H_y0, v2
  s_nop 0
  s_cbranch_vccz L_agot20
  s_add_u32 s43, s43, 1
  s_cmp_lt_u32 s43, 0x400000
  s_cbranch_scc1 L_aspin20
  s_branch L_agot20
L_aslow21:
  s_mov_b32 s43, 0
L_aspin21:
  s_sleep 1
  ds_read_b32 v2, v27 offset:16
  s_waitcnt lgkmcnt(0)
  v_cmp_gt_u32 vcc, EP_H_y1, v2
  s_nop 0
  s_cbranch_vccz L_agot21
  s_add_u32 s43, s43, 1
  s_cmp_lt_u32 s43, 0x400000
  s_cbranch_scc1 L_aspin21
  s_branch L_agot21
L_aslow22:
  s_mov_b32 s43, 0
L_aspin22:
  s_sleep 1
  ds_read_b32 v2, v27 offset:16
  s_waitcnt lgkmcnt(0)
  v_cmp_gt_u32 vcc, EP_H_y2, v2
  s_nop 0
  s_cbranch_vccz L_agot22
  s_add_u32 s43, s43, 1
  s_cmp_lt_u32 s43, 0x400000
  s_cbranch_scc1 L_aspin22
  s_branch L_agot22
L_aslow23:
  s_mov_b32 s43, 0
L_aspin23:
  s_sleep 1
  ds_read_b32 v2, v27 offset:16
  s_waitcnt lgkmcnt(0)
  v_cmp_gt_u32 vcc, EP_H_y3, v2
  s_nop 0
  s_cbranch_vccz L_agot23
  s_add_u32 s43, s43, 1
  s_cmp_lt_u32 s43, 0x400000
  s_cbranch_scc1 L_aspin23
  s_branch L_agot23
L_aslow24:
  s_mov_b32 s43, 0
L_aspin24:
  s_sleep 1
  ds_read_b32 v2, v27 offset:0
  s_waitcnt lgkmcnt(0)
  v_cmp_gt_u32 vcc, EP_G_ga, v2
  s_nop 0
  s_cbranch_vccz L_agot24
  s_add_u32 s43, s43, 1
  s_cmp_lt_u32 s43, 0x400000
  s_cbranch_scc1 L_aspin24
  s_branch L_agot24
L_aslow25:
  s_mov_b32 s43, 0
L_aspin25:
  s_sleep 1
  ds_read_b32 v2, v27 offset:16
  s_waitcnt lgkmcnt(0)
  v_cmp_gt_u32 vcc, EP_H_c0, v2
  s_nop 0
  s_cbranch_vccz L_agot25
  s_add_u32 s43, s43, 1
  s_cmp_lt_u32 s43, 0x400000
  s_cbranch_scc1 L_aspin25
  s_branch L_agot25
L_aslow27:
  s_mov_b32 s43, 0
L_aspin27:
  s_sleep 1
  ds_read_b32 v2, v27 offset:16
  s_waitcnt lgkmcnt(0)
  v_cmp_gt_u32 vcc, EP_H_c1, v2
  s_nop 0
  s_cbranch_vccz L_agot27
  s_add_u32 s43, s43, 1
  s_cmp_lt_u32 s43, 0x400000
  s_cbranch_scc1 L_aspin27
  s_branch L_agot27
L_aslow28:
  s_mov_b32 s43, 0
L_aspin28:
  s_sleep 1
  ds_read_b32 v2, v27 offset:16
  s_waitcnt lgkmcnt(0)
  v_cmp_gt_u32 vcc, EP_H_c2, v2
  s_nop 0
  s_cbranch_vccz L_agot28
  s_add_u32 s43, s43, 1
  s_cmp_lt_u32 s43, 0x400000
  s_cbranch_scc1 L_aspin28
  s_branch L_agot28
L_aslow29:
  s_mov_b32 s43, 0
L_aspin29:
  s_sleep 1
  ds_read_b32 v2, v27 offset:16
  s_waitcnt lgkmcnt(0)
  v_cmp_gt_u32 vcc, EP_H_c3, v2
  s_nop 0
  s_cbranch_vccz L_agot29
  s_add_u32 s43, s43, 1
  s_cmp_lt_u32 s43, 0x400000
  s_cbranch_scc1 L_aspin29
  s_branch L_agot29
L_aslow30:
  s_mov_b32 s43, 0
L_aspin30:
  s_sleep 1
  ds_read_b32 v2, v27 offset:16
  s_waitcnt lgkmcnt(0)
  v_cmp_gt_u32 vcc, EP_H_c4, v2
  s_nop 0
  s_cbranch_vccz L_agot30
  s_add_u32 s43, s43, 1
  s_cmp_lt_u32 s43, 0x400000
  s_cbranch_scc1 L_aspin30
  s_branch L_agot30
L_aslow31:
  s_mov_b32 s43, 0
L_aspin31:
  s_sleep 1
  ds_read_b32 v2, v27 offset:16
  s_waitcnt lgkmcnt(0)
  v_cmp_gt_u32 vcc, EP_H_c5, v2
  s_nop 0
  s_cbranch_vccz L_agot31
  s_add_u32 s43, s43, 1
  s_cmp_lt_u32 s43, 0x400000
  s_cbranch_scc1 L_aspin31
  s_branch L_agot31
L_aslow32:
  s_mov_b32 s43, 0
L_aspin32:
  s_sleep 1
  ds_read_b32 v2, v27 offset:16
  s_waitcnt lgkmcnt(0)
  v_cmp_gt_u32 vcc, EP_H_c6, v2
  s_nop 0
  s_cbranch_vccz L_agot32
  s_add_u32 s43, s43, 1
  s_cmp_lt_u32 s43, 0x400000
  s_cbranch_scc1 L_aspin32
  s_branch L_agot32
L_aslow33:
  s_mov_b32 s43, 0
L_aspin33:
  s_sleep 1
  ds_read_b32 v2, v27 offset:16
  s_waitcnt lgkmcnt(0)
  v_cmp_gt_u32 vcc, EP_H_c7, v2
  s_nop 0
  s_cbranch_vccz L_agot33
  s_add_u32 s43, s43, 1
  s_cmp_lt_u32 s43, 0x400000
  s_cbranch_scc1 L_aspin33
  s_branch L_agot33
L_aslow34:
  s_mov_b32 s43, 0
L_aspin34:
  s_sleep 1
  ds_read_b32 v2, v27 offset:0
  s_waitcnt lgkmcnt(0)
  v_cmp_gt_u32 vcc, EP_G_cs, v2
  s_nop 0
  s_cbranch_vccz L_agot34
  s_add_u32 s43, s43, 1
  s_cmp_lt_u32 s43, 0x400000
  s_cbranch_scc1 L_aspin34
  s_branch L_agot34
L_free:
  s_lshl_b32 s5, s2, 6
  s_add_u32 s5, s5, 262144
  s_mov_b32 s6, 0
  ds_read_b128 v[104:107], v114 offset:0
  ds_read_b128 v[108:111], v114 offset:4352
  ds_read_b128 v[132:135], v114 offset:8704
  ds_read_b128 v[136:139], v114 offset:13056
  v_add_u32 v144, 156736, v18
  ds_read_b128 v[140:143], v144
  s_waitcnt lgkmcnt(0)
  v_mov_b32 v144, v140
  s_cmp_lg_u32 s38, 0
  s_cbranch_scc1 L_nown35
  s_mov_b64 exec, 3
  buffer_store_dwordx4 v[140:143], v18, s[32:35], s53 offen sc1
  s_mov_b64 exec, -1
L_nown35:
  buffer_store_dwordx4 v[104:107], v115, s[32:35], s55 offen sc1
  s_add_u32 s55, s55, 65536
  buffer_store_dwordx4 v[108:111], v115, s[32:35], s55 offen sc1
  s_add_u32 s55, s55, 65536
  buffer_store_dwordx4 v[132:135], v115, s[32:35], s55 offen sc1
  s_add_u32 s55, s55, 65536
  buffer_store_dwordx4 v[136:139], v115, s[32:35], s55 offen sc1
  v_mov_b32 v3, EP_G_rel2
  s_mov_b64 exec, 1
  ds_write_b32 v28, v3
  s_mov_b64 exec, -1
  s_lshl_b32 s44, s56, 6
  v_xor_b32 v5, s44, v31
  v_add_u32 v32, s62, v5
  v_xor_b32 v33, 64, v32
  v_add_u32 v34, 0x10000, v32
  v_add_u32 v35, 0x10000, v33
  s_waitcnt vmcnt(0) lgkmcnt(0)
  s_mov_b64 exec, 1
  buffer_store_dword v20, v19, s[32:35], s4 offen sc1
  s_mov_b64 exec, -1
  s_cmp_eq_u32 s37, 29
  s_cbranch_scc1 L_sentG
L_sentG_done:
  v_mov_b32 v3, EP_G_rel3
  s_mov_b64 exec, 1
  ds_write_b32 v28, v3
  s_mov_b64 exec, -1
  s_cmp_eq_u32 s2, 224
  s_cbranch_scc1 L_spG
  ds_read_b32 v2, v27 offset:16
  s_waitcnt lgkmcnt(0)
  v_cmp_gt_u32 vcc, EP_H_c6, v2
  s_nop 0
  s_cbranch_vccnz L_aslow39
L_agot39:
  v_mov_b32 v3, EP_G_rel6
  s_mov_b64 exec, 1
  ds_write_b32 v28, v3
  s_mov_b64 exec, -1
  ds_read_b32 v2, v27 offset:16
  s_waitcnt lgkmcnt(0)
  v_cmp_gt_u32 vcc, EP_H_c7, v2
  s_nop 0
  s_cbranch_vccnz L_aslow40
L_agot40:
L_spG_done:
  v_mov_b32 v3, EP_G_cs
  s_mov_b64 exec, 1
  ds_write_b32 v28, v3
  s_mov_b64 exec, -1
  s_waitcnt vmcnt(0) lgkmcnt(0)
  s_nop 1
  s_branch L_join
L_sentG:
  s_lshr_b32 s44, s36, 1
  s_lshl_b32 s44, s44, 12
  s_lshr_b32 s45, s61, 2
  s_add_u32 s44, s44, s45
  s_add_u32 s44, s44, 16384
  v_add_u32 v56, s44, v18
  s_lshl_b32 s44, s36, 9
  s_add_u32 s44, s44, 114688
  v_lshl_add_u32 v57, v22, 4, s44
  s_lshl_b32 s46, s36, 8
  s_add_u32 s46, s46, 118784
  s_getreg_b32 s47, hwreg(HW_REG_XCC_ID, 0, 4)
  s_add_u32 s47, s47, s39
  buffer_load_dword v60, v19, s[32:35], s46 offen sc1
  buffer_load_dword v59, v57, s[32:35], 0 offen sc1
  ds_read_b32 v2, v27 offset:16
  s_waitcnt lgkmcnt(0)
  v_cmp_gt_u32 vcc, EP_H_c4, v2
  s_nop 0
  s_cbranch_vccnz L_aslow36
L_agot36:
  buffer_load_dword v58, v56, s[32:35], 0 offen sc1
  s_waitcnt vmcnt(0)
  v_cmp_ne_u32 vcc, s39, v58
  s_nop 0
  s_cbranch_vccnz L_slow37
L_got37:
  v_mov_b32 v3, EP_G_rel3
  s_mov_b64 exec, 1
  ds_write_b32 v28, v3
  s_mov_b64 exec, -1
  ds_read_b32 v2, v27 offset:0
  s_waitcnt lgkmcnt(0)
  v_cmp_gt_u32 vcc, EP_G_rel3, v2
  s_nop 0
  s_cbranch_vccnz L_aslow38
L_agot38:
  s_cmp_lg_u32 s38, 0
  s_cbranch_scc1 L_sentG_done
  v_cmp_ne_u32 vcc, s47, v59
  s_mov_b64 exec, 1
  s_cbranch_vccnz L_sentG_s
  buffer_store_dword v20, v19, s[32:35], s46 offen
  s_mov_b64 exec, -1
  s_branch L_sentG_done
L_sentG_s:
  buffer_store_dword v20, v19, s[32:35], s46 offen sc1
  s_mov_b64 exec, -1
  s_branch L_sentG_done
L_aslow36:
  s_mov_b32 s43, 0
L_aspin36:
  s_sleep 1
  ds_read_b32 v2, v27 offset:16
  s_waitcnt lgkmcnt(0)
  v_cmp_gt_u32 vcc, EP_H_c4, v2
  s_nop 0
  s_cbranch_vccz L_agot36
  s_add_u32 s43, s43, 1
  s_cmp_lt_u32 s43, 0x400000
  s_cbranch_scc1 L_aspin36
  s_branch L_agot36
L_slow37:
  s_mov_b32 s43, 0
L_spin37:
  s_mov_b64 exec, vcc
  s_sleep 3
  buffer_load_dword v58, v56, s[32:35], 0 offen sc1
  s_waitcnt vmcnt(0)
  v_cmp_ne_u32 vcc, s39, v58
  s_mov_b64 exec, -1
  s_cbranch_vccz L_got37
  s_add_u32 s43, s43, 1
  s_cmp_lt_u32 s43, 200000
  s_cbranch_scc1 L_spin37
  s_branch L_got37
L_aslow38:
  s_mov_b32 s43, 0
L_aspin38:
  s_sleep 1
  ds_read_b32 v2, v27 offset:0
  s_waitcnt lgkmcnt(0)
  v_cmp_gt_u32 vcc, EP_G_rel3, v2
  s_nop 0
  s_cbranch_vccz L_agot38
  s_add_u32 s43, s43, 1
  s_cmp_lt_u32 s43, 0x400000
  s_cbranch_scc1 L_aspin38
  s_branch L_agot38
L_aslow39:
  s_mov_b32 s43, 0
L_aspin39:
  s_sleep 1
  ds_read_b32 v2, v27 offset:16
  s_waitcnt lgkmcnt(0)
  v_cmp_gt_u32 vcc, EP_H_c6, v2
  s_nop 0
  s_cbranch_vccz L_agot39
  s_add_u32 s43, s43, 1
  s_cmp_lt_u32 s43, 0x400000
  s_cbranch_scc1 L_aspin39
  s_branch L_agot39
L_aslow40:
  s_mov_b32 s43, 0
L_aspin40:
  s_sleep 1
  ds_read_b32 v2, v27 offset:16
  s_waitcnt lgkmcnt(0)
  v_cmp_gt_u32 vcc, EP_H_c7, v2
  s_nop 0
  s_cbranch_vccz L_agot40
  s_add_u32 s43, s43, 1
  s_cmp_lt_u32 s43, 0x400000
  s_cbranch_scc1 L_aspin40
  s_branch L_agot40
L_spG:
  s_lshl_b32 s44, s38, 4
  v_lshl_add_u32 v116, v17, 8, v16
  v_add_u32 v116, s44, v116
  v_add_u32 v4, 0, v116
  v_bfe_u32 v5, v4, 4, 2
  v_lshrrev_b32 v6, 9, v4
  v_lshl_add_u32 v5, v5, 2, v6
  v_and_b32 v6, 15, v4
  v_lshl_add_u32 v5, v5, 4, v6
  v_bfe_u32 v6, v4, 6, 3
  v_lshlrev_b32 v7, 2, v6
  v_lshl_add_u32 v7, v5, 5, v7
  v_add_u32 v64, 147456, v7
  v_lshrrev_b32 v7, 2, v6
  v_bfe_u32 v4, v5, 2, 2
  v_xor_b32 v7, v7, v4
  v_xor_b32 v7, 2, v7
  v_and_b32 v6, 3, v6
  v_lshlrev_b32 v6, 2, v6
  v_lshl_add_u32 v6, v7, 4, v6
  v_lshl_add_u32 v6, v5, 6, v6
  v_add_u32 v56, 131072, v6
  v_sub_u32 v4, 2048, v116
  v_and_b32 v4, 2047, v4
  v_bfe_u32 v5, v4, 4, 2
  v_lshrrev_b32 v6, 9, v4
  v_lshl_add_u32 v5, v5, 2, v6
  v_and_b32 v6, 15, v4
  v_lshl_add_u32 v5, v5, 4, v6
  v_bfe_u32 v6, v4, 6, 3
  v_lshlrev_b32 v7, 2, v6
  v_lshl_add_u32 v7, v5, 5, v7
  v_add_u32 v80, 147456, v7
  v_lshrrev_b32 v7, 2, v6
  v_bfe_u32 v4, v5, 2, 2
  v_xor_b32 v7, v7, v4
  v_xor_b32 v7, 2, v7
  v_and_b32 v6, 3, v6
  v_lshlrev_b32 v6, 2, v6
  v_lshl_add_u32 v6, v7, 4, v6
  v_lshl_add_u32 v6, v5, 6, v6
  v_add_u32 v72, 131072, v6
  v_add_u32 v4, 64, v116
  v_bfe_u32 v5, v4, 4, 2
  v_lshrrev_b32 v6, 9, v4
  v_lshl_add_u32 v5, v5, 2, v6
  v_and_b32 v6, 15, v4
  v_lshl_add_u32 v5, v5, 4, v6
  v_bfe_u32 v6, v4, 6, 3
  v_lshlrev_b32 v7, 2, v6
  v_lshl_add_u32 v7, v5, 5, v7
  v_add_u32 v65, 147456, v7
  v_lshrrev_b32 v7, 2, v6
  v_bfe_u32 v4, v5, 2, 2
  v_xor_b32 v7, v7, v4
  v_xor_b32 v7, 2, v7
  v_and_b32 v6, 3, v6
  v_lshlrev_b32 v6, 2, v6
  v_lshl_add_u32 v6, v7, 4, v6
  v_lshl_add_u32 v6, v5, 6, v6
  v_add_u32 v57, 131072, v6
  v_sub_u32 v4, 1984, v116
  v_and_b32 v4, 2047, v4
  v_bfe_u32 v5, v4, 4, 2
  v_lshrrev_b32 v6, 9, v4
  v_lshl_add_u32 v5, v5, 2, v6
  v_and_b32 v6, 15, v4
  v_lshl_add_u32 v5, v5, 4, v6
  v_bfe_u32 v6, v4, 6, 3
  v_lshlrev_b32 v7, 2, v6
  v_lshl_add_u32 v7, v5, 5, v7
  v_add_u32 v81, 147456, v7
  v_lshrrev_b32 v7, 2, v6
  v_bfe_u32 v4, v5, 2, 2
  v_xor_b32 v7, v7, v4
  v_xor_b32 v7, 2, v7
  v_and_b32 v6, 3, v6
  v_lshlrev_b32 v6, 2, v6
  v_lshl_add_u32 v6, v7, 4, v6
  v_lshl_add_u32 v6, v5, 6, v6
  v_add_u32 v73, 131072, v6
  v_add_u32 v4, 128, v116
  v_bfe_u32 v5, v4, 4, 2
  v_lshrrev_b32 v6, 9, v4
  v_lshl_add_u32 v5, v5, 2, v6
  v_and_b32 v6, 15, v4
  v_lshl_add_u32 v5, v5, 4, v6
  v_bfe_u32 v6, v4, 6, 3
  v_lshlrev_b32 v7, 2, v6
  v_lshl_add_u32 v7, v5, 5, v7
  v_add_u32 v66, 147456, v7
  v_lshrrev_b32 v7, 2, v6
  v_bfe_u32 v4, v5, 2, 2
  v_xor_b32 v7, v7, v4
  v_xor_b32 v7, 2, v7
  v_and_b32 v6, 3, v6
  v_lshlrev_b32 v6, 2, v6
  v_lshl_add_u32 v6, v7, 4, v6
  v_lshl_add_u32 v6, v5, 6, v6
  v_add_u32 v58, 131072, v6
  v_sub_u32 v4, 1920, v116
  v_and_b32 v4, 2047, v4
  v_bfe_u32 v5, v4, 4, 2
  v_lshrrev_b32 v6, 9, v4
  v_lshl_add_u32 v5, v5, 2, v6
  v_and_b32 v6, 15, v4
  v_lshl_add_u32 v5, v5, 4, v6
  v_bfe_u32 v6, v4, 6, 3
  v_lshlrev_b32 v7, 2, v6
  v_lshl_add_u32 v7, v5, 5, v7
  v_add_u32 v82, 147456, v7
  v_lshrrev_b32 v7, 2, v6
  v_bfe_u32 v4, v5, 2, 2
  v_xor_b32 v7, v7, v4
  v_xor_b32 v7, 2, v7
  v_and_b32 v6, 3, v6
  v_lshlrev_b32 v6, 2, v6
  v_lshl_add_u32 v6, v7, 4, v6
  v_lshl_add_u32 v6, v5, 6, v6
  v_add_u32 v74, 131072, v6
  v_add_u32 v4, 192, v116
  v_bfe_u32 v5, v4, 4, 2
  v_lshrrev_b32 v6, 9, v4
  v_lshl_add_u32 v5, v5, 2, v6
  v_and_b32 v6, 15, v4
  v_lshl_add_u32 v5, v5, 4, v6
  v_bfe_u32 v6, v4, 6, 3
  v_lshlrev_b32 v7, 2, v6
  v_lshl_add_u32 v7, v5, 5, v7
  v_add_u32 v67, 147456, v7
  v_lshrrev_b32 v7, 2, v6
  v_bfe_u32 v4, v5, 2, 2
  v_xor_b32 v7, v7, v4
  v_xor_b32 v7, 2, v7
  v_and_b32 v6, 3, v6
  v_lshlrev_b32 v6, 2, v6
  v_lshl_add_u32 v6, v7, 4, v6
  v_lshl_add_u32 v6, v5, 6, v6
  v_add_u32 v59, 131072, v6
  v_sub_u32 v4, 1856, v116
  v_and_b32 v4, 2047, v4
  v_bfe_u32 v5, v4, 4, 2
  v_lshrrev_b32 v6, 9, v4
  v_lshl_add_u32 v5, v5, 2, v6
  v_and_b32 v6, 15, v4
  v_lshl_add_u32 v5, v5, 4, v6
  v_bfe_u32 v6, v4, 6, 3
  v_lshlrev_b32 v7, 2, v6
  v_lshl_add_u32 v7, v5, 5, v7
  v_add_u32 v83, 147456, v7
  v_lshrrev_b32 v7, 2, v6
  v_bfe_u32 v4, v5, 2, 2
  v_xor_b32 v7, v7, v4
  v_xor_b32 v7, 2, v7
  v_and_b32 v6, 3, v6
  v_lshlrev_b32 v6, 2, v6
  v_lshl_add_u32 v6, v7, 4, v6
  v_lshl_add_u32 v6, v5, 6, v6
  v_add_u32 v75, 131072, v6
  v_add_u32 v4, 1024, v116
  v_bfe_u32 v5, v4, 4, 2
  v_lshrrev_b32 v6, 9, v4
  v_lshl_add_u32 v5, v5, 2, v6
  v_and_b32 v6, 15, v4
  v_lshl_add_u32 v5, v5, 4, v6
  v_bfe_u32 v6, v4, 6, 3
  v_lshlrev_b32 v7, 2, v6
  v_lshl_add_u32 v7, v5, 5, v7
  v_add_u32 v68, 147456, v7
  v_lshrrev_b32 v7, 2, v6
  v_bfe_u32 v4, v5, 2, 2
  v_xor_b32 v7, v7, v4
  v_xor_b32 v7, 2, v7
  v_and_b32 v6, 3, v6
  v_lshlrev_b32 v6, 2, v6
  v_lshl_add_u32 v6, v7, 4, v6
  v_lshl_add_u32 v6, v5, 6, v6
  v_add_u32 v60, 131072, v6
  v_sub_u32 v4, 1024, v116
  v_and_b32 v4, 2047, v4
  v_bfe_u32 v5, v4, 4, 2
  v_lshrrev_b32 v6, 9, v4
  v_lshl_add_u32 v5, v5, 2, v6
  v_and_b32 v6, 15, v4
  v_lshl_add_u32 v5, v5, 4, v6
  v_bfe_u32 v6, v4, 6, 3
  v_lshlrev_b32 v7, 2, v6
  v_lshl_add_u32 v7, v5, 5, v7
  v_add_u32 v84, 147456, v7
  v_lshrrev_b32 v7, 2, v6
  v_bfe_u32 v4, v5, 2, 2
  v_xor_b32 v7, v7, v4
  v_xor_b32 v7, 2, v7
  v_and_b32 v6, 3, v6
  v_lshlrev_b32 v6, 2, v6
  v_lshl_add_u32 v6, v7, 4, v6
  v_lshl_add_u32 v6, v5, 6, v6
  v_add_u32 v76, 131072, v6
  v_add_u32 v4, 1088, v116
  v_bfe_u32 v5, v4, 4, 2
  v_lshrrev_b32 v6, 9, v4
  v_lshl_add_u32 v5, v5, 2, v6
  v_and_b32 v6, 15, v4
  v_lshl_add_u32 v5, v5, 4, v6
  v_bfe_u32 v6, v4, 6, 3
  v_lshlrev_b32 v7, 2, v6
  v_lshl_add_u32 v7, v5, 5, v7
  v_add_u32 v69, 147456, v7
  v_lshrrev_b32 v7, 2, v6
  v_bfe_u32 v4, v5, 2, 2
  v_xor_b32 v7, v7, v4
  v_xor_b32 v7, 2, v7
  v_and_b32 v6, 3, v6
  v_lshlrev_b32 v6, 2, v6
  v_lshl_add_u32 v6, v7, 4, v6
  v_lshl_add_u32 v6, v5, 6, v6
  v_add_u32 v61, 131072, v6
  v_sub_u32 v4, 960, v116
  v_and_b32 v4, 2047, v4
  v_bfe_u32 v5, v4, 4, 2
  v_lshrrev_b32 v6, 9, v4
  v_lshl_add_u32 v5, v5, 2, v6
  v_and_b32 v6, 15, v4
  v_lshl_add_u32 v5, v5, 4, v6
  v_bfe_u32 v6, v4, 6, 3
  v_lshlrev_b32 v7, 2, v6
  v_lshl_add_u32 v7, v5, 5, v7
  v_add_u32 v85, 147456, v7
  v_lshrrev_b32 v7, 2, v6
  v_bfe_u32 v4, v5, 2, 2
  v_xor_b32 v7, v7, v4
  v_xor_b32 v7, 2, v7
  v_and_b32 v6, 3, v6
  v_lshlrev_b32 v6, 2, v6
  v_lshl_add_u32 v6, v7, 4, v6
  v_lshl_add_u32 v6, v5, 6, v6
  v_add_u32 v77, 131072, v6
  v_add_u32 v4, 1152, v116
  v_bfe_u32 v5, v4, 4, 2
  v_lshrrev_b32 v6, 9, v4
  v_lshl_add_u32 v5, v5, 2, v6
  v_and_b32 v6, 15, v4
  v_lshl_add_u32 v5, v5, 4, v6
  v_bfe_u32 v6, v4, 6, 3
  v_lshlrev_b32 v7, 2, v6
  v_lshl_add_u32 v7, v5, 5, v7
  v_add_u32 v70, 147456, v7
  v_lshrrev_b32 v7, 2, v6
  v_bfe_u32 v4, v5, 2, 2
  v_xor_b32 v7, v7, v4
  v_xor_b32 v7, 2, v7
  v_and_b32 v6, 3, v6
  v_lshlrev_b32 v6, 2, v6
  v_lshl_add_u32 v6, v7, 4, v6
  v_lshl_add_u32 v6, v5, 6, v6
  v_add_u32 v62, 131072, v6
  v_sub_u32 v4, 896, v116
  v_and_b32 v4, 2047, v4
  v_bfe_u32 v5, v4, 4, 2
  v_lshrrev_b32 v6, 9, v4
  v_lshl_add_u32 v5, v5, 2, v6
  v_and_b32 v6, 15, v4
  v_lshl_add_u32 v5, v5, 4, v6
  v_bfe_u32 v6, v4, 6, 3
  v_lshlrev_b32 v7, 2, v6
  v_lshl_add_u32 v7, v5, 5, v7
  v_add_u32 v86, 147456, v7
  v_lshrrev_b32 v7, 2, v6
  v_bfe_u32 v4, v5, 2, 2
  v_xor_b32 v7, v7, v4
  v_xor_b32 v7, 2, v7
  v_and_b32 v6, 3, v6
  v_lshlrev_b32 v6, 2, v6
  v_lshl_add_u32 v6, v7, 4, v6
  v_lshl_add_u32 v6, v5, 6, v6
  v_add_u32 v78, 131072, v6
  v_add_u32 v4, 1216, v116
  v_bfe_u32 v5, v4, 4, 2
  v_lshrrev_b32 v6, 9, v4
  v_lshl_add_u32 v5, v5, 2, v6
  v_and_b32 v6, 15, v4
  v_lshl_add_u32 v5, v5, 4, v6
  v_bfe_u32 v6, v4, 6, 3
  v_lshlrev_b32 v7, 2, v6
  v_lshl_add_u32 v7, v5, 5, v7
  v_add_u32 v71, 147456, v7
  v_lshrrev_b32 v7, 2, v6
  v_bfe_u32 v4, v5, 2, 2
  v_xor_b32 v7, v7, v4
  v_xor_b32 v7, 2, v7
  v_and_b32 v6, 3, v6
  v_lshlrev_b32 v6, 2, v6
  v_lshl_add_u32 v6, v7, 4, v6
  v_lshl_add_u32 v6, v5, 6, v6
  v_add_u32 v63, 131072, v6
  v_sub_u32 v4, 832, v116
  v_and_b32 v4, 2047, v4
  v_bfe_u32 v5, v4, 4, 2
  v_lshrrev_b32 v6, 9, v4
  v_lshl_add_u32 v5, v5, 2, v6
  v_and_b32 v6, 15, v4
  v_lshl_add_u32 v5, v5, 4, v6
  v_bfe_u32 v6, v4, 6, 3
  v_lshlrev_b32 v7, 2, v6
  v_lshl_add_u32 v7, v5, 5, v7
  v_add_u32 v87, 147456, v7
  v_lshrrev_b32 v7, 2, v6
  v_bfe_u32 v4, v5, 2, 2
  v_xor_b32 v7, v7, v4
  v_xor_b32 v7, 2, v7
  v_and_b32 v6, 3, v6
  v_lshlrev_b32 v6, 2, v6
  v_lshl_add_u32 v6, v7, 4, v6
  v_lshl_add_u32 v6, v5, 6, v6
  v_add_u32 v79, 131072, v6
  s_add_u32 s44, s62, 98304
  v_add_u32 v116, s44, v18
  ds_read_b32 v2, v27 offset:16
  s_waitcnt lgkmcnt(0)
  v_cmp_gt_u32 vcc, EP_H_c6, v2
  s_nop 0
  s_cbranch_vccnz L_aslow41
L_agot41:
  v_mov_b32 v3, EP_G_rel6
  s_mov_b64 exec, 1
  ds_write_b32 v28, v3
  s_mov_b64 exec, -1
  ds_read_b32 v2, v27 offset:16
  s_waitcnt lgkmcnt(0)
  v_cmp_gt_u32 vcc, EP_H_xc, v2
  s_nop 0
  s_cbranch_vccnz L_aslow42
L_agot42:
  ds_read_b32 v56, v56
  ds_read_b32 v72, v72
  ds_read_b32 v64, v64
  ds_read_b32 v80, v80
  ds_read_b32 v57, v57
  ds_read_b32 v73, v73
  ds_read_b32 v65, v65
  ds_read_b32 v81, v81
  ds_read_b32 v58, v58
  ds_read_b32 v74, v74
  ds_read_b32 v66, v66
  ds_read_b32 v82, v82
  ds_read_b32 v59, v59
  ds_read_b32 v75, v75
  ds_read_b32 v67, v67
  ds_read_b32 v83, v83
  ds_read_b32 v60, v60
  ds_read_b32 v76, v76
  ds_read_b32 v68, v68
  ds_read_b32 v84, v84
  ds_read_b32 v61, v61
  ds_read_b32 v77, v77
  ds_read_b32 v69, v69
  ds_read_b32 v85, v85
  ds_read_b32 v62, v62
  ds_read_b32 v78, v78
  ds_read_b32 v70, v70
  ds_read_b32 v86, v86
  ds_read_b32 v63, v63
  ds_read_b32 v79, v79
  ds_read_b32 v71, v71
  ds_read_b32 v87, v87
  ds_read_b32 v2, v27 offset:16
  s_waitcnt lgkmcnt(0)
  v_cmp_gt_u32 vcc, EP_H_c7, v2
  s_nop 0
  s_cbranch_vccnz L_aslow43
L_agot43:
  v_lshlrev_b32 v4, 16, v56
  v_and_b32 v5, 0xffff0000, v56
  v_lshlrev_b32 v6, 16, v72
  v_and_b32 v7, 0xffff0000, v72
  v_lshlrev_b32 v8, 16, v64
  v_and_b32 v9, 0xffff0000, v64
  v_lshlrev_b32 v10, 16, v80
  v_and_b32 v11, 0xffff0000, v80
  v_add_f32 v4, v4, v6
  v_sub_f32 v5, v5, v7
  v_add_f32 v8, v8, v10
  v_sub_f32 v9, v9, v11
  v_add_f32 v88, v4, v8
  v_add_f32 v89, v5, v9
  v_sub_f32 v90, v4, v8
  v_sub_f32 v91, v5, v9
  v_mul_f32 v88, 0x3e000000, v88
  v_mul_f32 v89, 0x3e000000, v89
  v_mul_f32 v90, 0x3e000000, v90
  v_mul_f32 v91, 0x3e000000, v91
  ds_write_b128 v116, v[88:91] offset:0
  v_lshlrev_b32 v4, 16, v57
  v_and_b32 v5, 0xffff0000, v57
  v_lshlrev_b32 v6, 16, v73
  v_and_b32 v7, 0xffff0000, v73
  v_lshlrev_b32 v8, 16, v65
  v_and_b32 v9, 0xffff0000, v65
  v_lshlrev_b32 v10, 16, v81
  v_and_b32 v11, 0xffff0000, v81
  v_add_f32 v4, v4, v6
  v_sub_f32 v5, v5, v7
  v_add_f32 v8, v8, v10
  v_sub_f32 v9, v9, v11
  v_add_f32 v92, v4, v8
  v_add_f32 v93, v5, v9
  v_sub_f32 v94, v4, v8
  v_sub_f32 v95, v5, v9
  v_mul_f32 v92, 0x3e000000, v92
  v_mul_f32 v93, 0x3e000000, v93
  v_mul_f32 v94, 0x3e000000, v94
  v_mul_f32 v95, 0x3e000000, v95
  ds_write_b128 v116, v[92:95] offset:1024
  v_lshlrev_b32 v4, 16, v58
  v_and_b32 v5, 0xffff0000, v58
  v_lshlrev_b32 v6, 16, v74
  v_and_b32 v7, 0xffff0000, v74
  v_lshlrev_b32 v8, 16, v66
  v_and_b32 v9, 0xffff0000, v66
  v_lshlrev_b32 v10, 16, v82
  v_and_b32 v11, 0xffff0000, v82
  v_add_f32 v4, v4, v6
  v_sub_f32 v5, v5, v7
  v_add_f32 v8, v8, v10
  v_sub_f32 v9, v9, v11
  v_add_f32 v96, v4, v8
  v_add_f32 v97, v5, v9
  v_sub_f32 v98, v4, v8
  v_sub_f32 v99, v5, v9
  v_mul_f32 v96, 0x3e000000, v96
  v_mul_f32 v97, 0x3e000000, v97
  v_mul_f32 v98, 0x3e000000, v98
  v_mul_f32 v99, 0x3e000000, v99
  ds_write_b128 v116, v[96:99] offset:2048
  v_lshlrev_b32 v4, 16, v59
  v_and_b32 v5, 0xffff0000, v59
  v_lshlrev_b32 v6, 16, v75
  v_and_b32 v7, 0xffff0000, v75
  v_lshlrev_b32 v8, 16, v67
  v_and_b32 v9, 0xffff0000, v67
  v_lshlrev_b32 v10, 16, v83
  v_and_b32 v11, 0xffff0000, v83
  v_add_f32 v4, v4, v6
  v_sub_f32 v5, v5, v7
  v_add_f32 v8, v8, v10
  v_sub_f32 v9, v9, v11
  v_add_f32 v100, v4, v8
  v_add_f32 v101, v5, v9
  v_sub_f32 v102, v4, v8
  v_sub_f32 v103, v5, v9
  v_mul_f32 v100, 0x3e000000, v100
  v_mul_f32 v101, 0x3e000000, v101
  v_mul_f32 v102, 0x3e000000, v102
  v_mul_f32 v103, 0x3e000000, v103
  ds_write_b128 v116, v[100:103] offset:3072
  v_lshlrev_b32 v4, 16, v60
  v_and_b32 v5, 0xffff0000, v60
  v_lshlrev_b32 v6, 16, v76
  v_and_b32 v7, 0xffff0000, v76
  v_lshlrev_b32 v8, 16, v68
  v_and_b32 v9, 0xffff0000, v68
  v_lshlrev_b32 v10, 16, v84
  v_and_b32 v11, 0xffff0000, v84
  v_add_f32 v4, v4, v6
  v_sub_f32 v5, v5, v7
  v_add_f32 v8, v8, v10
  v_sub_f32 v9, v9, v11
  v_add_f32 v88, v4, v8
  v_add_f32 v89, v5, v9
  v_sub_f32 v90, v4, v8
  v_sub_f32 v91, v5, v9
  v_mul_f32 v88, 0x3e000000, v88
  v_mul_f32 v89, 0x3e000000, v89
  v_mul_f32 v90, 0x3e000000, v90
  v_mul_f32 v91, 0x3e000000, v91
  ds_write_b128 v116, v[88:91] offset:4096
  v_lshlrev_b32 v4, 16, v61
  v_and_b32 v5, 0xffff0000, v61
  v_lshlrev_b32 v6, 16, v77
  v_and_b32 v7, 0xffff0000, v77
  v_lshlrev_b32 v8, 16, v69
  v_and_b32 v9, 0xffff0000, v69
  v_lshlrev_b32 v10, 16, v85
  v_and_b32 v11, 0xffff0000, v85
  v_add_f32 v4, v4, v6
  v_sub_f32 v5, v5, v7
  v_add_f32 v8, v8, v10
  v_sub_f32 v9, v9, v11
  v_add_f32 v92, v4, v8
  v_add_f32 v93, v5, v9
  v_sub_f32 v94, v4, v8
  v_sub_f32 v95, v5, v9
  v_mul_f32 v92, 0x3e000000, v92
  v_mul_f32 v93, 0x3e000000, v93
  v_mul_f32 v94, 0x3e000000, v94
  v_mul_f32 v95, 0x3e000000, v95
  ds_write_b128 v116, v[92:95] offset:5120
  v_lshlrev_b32 v4, 16, v62
  v_and_b32 v5, 0xffff0000, v62
  v_lshlrev_b32 v6, 16, v78
  v_and_b32 v7, 0xffff0000, v78
  v_lshlrev_b32 v8, 16, v70
  v_and_b32 v9, 0xffff0000, v70
  v_lshlrev_b32 v10, 16, v86
  v_and_b32 v11, 0xffff0000, v86
  v_add_f32 v4, v4, v6
  v_sub_f32 v5, v5, v7
  v_add_f32 v8, v8, v10
  v_sub_f32 v9, v9, v11
  v_add_f32 v96, v4, v8
  v_add_f32 v97, v5, v9
  v_sub_f32 v98, v4, v8
  v_sub_f32 v99, v5, v9
  v_mul_f32 v96, 0x3e000000, v96
  v_mul_f32 v97, 0x3e000000, v97
  v_mul_f32 v98, 0x3e000000, v98
  v_mul_f32 v99, 0x3e000000, v99
  ds_write_b128 v116, v[96:99] offset:6144
  v_lshlrev_b32 v4, 16, v63
  v_and_b32 v5, 0xffff0000, v63
  v_lshlrev_b32 v6, 16, v79
  v_and_b32 v7, 0xffff0000, v79
  v_lshlrev_b32 v8, 16, v71
  v_and_b32 v9, 0xffff0000, v71
  v_lshlrev_b32 v10, 16, v87
  v_and_b32 v11, 0xffff0000, v87
  v_add_f32 v4, v4, v6
  v_sub_f32 v5, v5, v7
  v_add_f32 v8, v8, v10
  v_sub_f32 v9, v9, v11
  v_add_f32 v100, v4, v8
  v_add_f32 v101, v5, v9
  v_sub_f32 v102, v4, v8
  v_sub_f32 v103, v5, v9
  v_mul_f32 v100, 0x3e000000, v100
  v_mul_f32 v101, 0x3e000000, v101
  v_mul_f32 v102, 0x3e000000, v102
  v_mul_f32 v103, 0x3e000000, v103
  ds_write_b128 v116, v[100:103] offset:7168
  v_mov_b32 v3, EP_G_cs
  s_mov_b64 exec, 1
  ds_write_b32 v28, v3
  s_mov_b64 exec, -1
  ds_read_b32 v2, v27 offset:16
  s_waitcnt lgkmcnt(0)
  v_cmp_gt_u32 vcc, EP_H_sp1, v2
  s_nop 0
  s_cbranch_vccnz L_aslow44
L_agot44:
  s_waitcnt vmcnt(0) lgkmcnt(0)
  s_branch L_spG_done
L_aslow41:
  s_mov_b32 s43, 0
L_aspin41:
  s_sleep 1
  ds_read_b32 v2, v27 offset:16
  s_waitcnt lgkmcnt(0)
  v_cmp_gt_u32 vcc, EP_H_c6, v2
  s_nop 0
  s_cbranch_vccz L_agot41
  s_add_u32 s43, s43, 1
  s_cmp_lt_u32 s43, 0x400000
  s_cbranch_scc1 L_aspin41
  s_branch L_agot41
L_aslow42:
  s_mov_b32 s43, 0
L_aspin42:
  s_sleep 1
  ds_read_b32 v2, v27 offset:16
  s_waitcnt lgkmcnt(0)
  v_cmp_gt_u32 vcc, EP_H_xc, v2
  s_nop 0
  s_cbranch_vccz L_agot42
  s_add_u32 s43, s43, 1
  s_cmp_lt_u32 s43, 0x400000
  s_cbranch_scc1 L_aspin42
  s_branch L_agot42
L_aslow43:
  s_mov_b32 s43, 0
L_aspin43:
  s_sleep 1
  ds_read_b32 v2, v27 offset:16
  s_waitcnt lgkmcnt(0)
  v_cmp_gt_u32 vcc, EP_H_c7, v2
  s_nop 0
  s_cbranch_vccz L_agot43
  s_add_u32 s43, s43, 1
  s_cmp_lt_u32 s43, 0x400000
  s_cbranch_scc1 L_aspin43
  s_branch L_agot43
L_aslow44:
  s_mov_b32 s43, 0
L_aspin44:
  s_sleep 1
  ds_read_b32 v2, v27 offset:16
  s_waitcnt lgkmcnt(0)
  v_cmp_gt_u32 vcc, EP_H_sp1, v2
  s_nop 0
  s_cbranch_vccz L_agot44
  s_add_u32 s43, s43, 1
  s_cmp_lt_u32 s43, 0x400000
  s_cbranch_scc1 L_aspin44
  s_branch L_agot44
L_fm45:
  buffer_store_dword v20, v19, s[32:35], s5 offen sc1
  s_branch L_fmd45
L_aslow46:
  s_mov_b32 s43, 0
L_aspin46:
  s_sleep 1
  ds_read_b32 v2, v27 offset:16
  s_waitcnt lgkmcnt(0)
  v_cmp_gt_u32 vcc, EP_H_xc, v2
  s_nop 0
  s_cbranch_vccz L_agot46
  s_add_u32 s43, s43, 1
  s_cmp_lt_u32 s43, 0x400000
  s_cbranch_scc1 L_aspin46
  s_branch L_agot46
L_aslow47:
  s_mov_b32 s43, 0
L_aspin47:
  s_sleep 1
  ds_read_b32 v2, v27 offset:16
  s_waitcnt lgkmcnt(0)
  v_cmp_gt_u32 vcc, EP_H_w2, v2
  s_nop 0
  s_cbranch_vccz L_agot47
  s_add_u32 s43, s43, 1
  s_cmp_lt_u32 s43, 0x400000
  s_cbranch_scc1 L_aspin47
  s_branch L_agot47
L_slow48:
  s_mov_b32 s43, 0
L_spin48:
  s_mov_b64 exec, vcc
  s_sleep 3
  buffer_load_dword v24, v16, s[32:35], 0 offen sc1
  s_waitcnt vmcnt(0)
  v_cmp_ne_u32 vcc, s39, v24
  s_mov_b64 exec, -1
  s_cbranch_vccz L_got48
  s_add_u32 s43, s43, 1
  s_cmp_lt_u32 s43, 200000
  s_cbranch_scc1 L_spin48
  s_branch L_got48
L_aslow49:
  s_mov_b32 s43, 0
L_aspin49:
  s_sleep 1
  ds_read_b32 v2, v27 offset:16
  s_waitcnt lgkmcnt(0)
  v_cmp_gt_u32 vcc, EP_H_xt, v2
  s_nop 0
  s_cbranch_vccz L_agot49
  s_add_u32 s43, s43, 1
  s_cmp_lt_u32 s43, 0x400000
  s_cbranch_scc1 L_aspin49
  s_branch L_agot49
L_aslow50:
  s_mov_b32 s43, 0
L_aspin50:
  s_sleep 1
  ds_read_b32 v2, v27 offset:0
  s_waitcnt lgkmcnt(0)
  v_cmp_gt_u32 vcc, EP_G_y, v2
  s_nop 0
  s_cbranch_vccz L_agot50
  s_add_u32 s43, s43, 1
  s_cmp_lt_u32 s43, 0x400000
  s_cbranch_scc1 L_aspin50
  s_branch L_agot50
L_aslow51:
  s_mov_b32 s43, 0
L_aspin51:
  s_sleep 1
  ds_read_b32 v2, v27 offset:16
  s_waitcnt lgkmcnt(0)
  v_cmp_gt_u32 vcc, EP_H_done, v2
  s_nop 0
  s_cbranch_vccz L_agot51
  s_add_u32 s43, s43, 1
  s_cmp_lt_u32 s43, 0x400000
  s_cbranch_scc1 L_aspin51
  s_branch L_agot51
L_code_end:
.section .rodata,"a"
.p2align 6
.amdhsa_kernel recurrent_scan__spectral_gfnet__dense_activation_relu__prompt_kernel
  .amdhsa_next_free_vgpr 256
  .amdhsa_next_free_sgpr 102
  .amdhsa_accum_offset 256
  .amdhsa_group_segment_fixed_size 0
  .amdhsa_kernarg_size 72
  .amdhsa_user_sgpr_count 2
  .amdhsa_user_sgpr_kernarg_segment_ptr 1
  .amdhsa_system_sgpr_workgroup_id_x 1
  .amdhsa_float_denorm_mode_32 3
.end_amdhsa_kernel
```
